```python
import torch

def _softmax(x, axis=-1):
    return torch.softmax(x, dim=axis)
def _gelu(x):
    return torch.nn.functional.gelu(x, approximate="tanh")
def _silu(x):
    return torch.nn.functional.silu(x)
def _sigmoid(x):
    return torch.sigmoid(x)
def _layernorm(x, axis=-1, eps=1e-5):
    m = x.mean(dim=axis, keepdim=True)
    v = x.var(dim=axis, keepdim=True, unbiased=False)
    return (x - m) / torch.sqrt(v + eps)
def _scatter_add(tgt, idx, src, axis=0):
    return tgt.clone().index_add_(axis, idx, src)
def _segment_sum(src, seg, n):
    out = torch.zeros((n,) + src.shape[1:], dtype=src.dtype)
    return out.index_add_(0, seg, src)
def _pad(x, pw):
    flat = tuple(v for pair in reversed(pw) for v in pair)
    return torch.nn.functional.pad(x, flat)

kernel_name = 'parallel_sum__mha_block__glu_gated_geglu__prompt'

def setup_inputs():

    _w = (lambda a: (lambda t: t.to(torch.bfloat16) if t.is_floating_point() else t)(torch.as_tensor(a)))
    def _A_setup():
        B, S, D, H = 1, 2048, 448, 16
        return {
            "x": _w((lambda *s: torch.randn(*s, dtype=torch.bfloat16) * 0.05)(B, S, D)),
            "wqkv": _w((lambda *s: torch.randn(*s, dtype=torch.bfloat16) * 0.05)(D, 3 * D)),
            "wo": _w((lambda *s: torch.randn(*s, dtype=torch.bfloat16) * 0.05)(D, D)),
        }
    _A_in = _A_setup()

    def _B_setup():
        B, S, Dm, Df = 1, 2048, 448, 1792
        return {
            "x": _w((lambda *s: torch.randn(*s, dtype=torch.bfloat16) * 0.05)(B, S, Dm)),
            "w_gate": _w((lambda *s: torch.randn(*s, dtype=torch.bfloat16) * 0.4)(Dm, Df) * (Dm ** -0.5)),
            "w_up": _w((lambda *s: torch.randn(*s, dtype=torch.bfloat16) * 0.4)(Dm, Df) * (Dm ** -0.5)),
            "w_down": _w((lambda *s: torch.randn(*s, dtype=torch.bfloat16) * 0.4)(Df, Dm) * (Df ** -0.5)),
        }
    _B_in = _B_setup()

    return {
        "A_x": _A_in["x"],
        "A_wqkv": _A_in["wqkv"],
        "A_wo": _A_in["wo"],
        "B_x": _B_in["x"],
        "B_w_gate": _B_in["w_gate"],
        "B_w_up": _B_in["w_up"],
        "B_w_down": _B_in["w_down"],
    }

def reference(A_x, A_wqkv, A_wo, B_x, B_w_gate, B_w_up, B_w_down):
    def _A_ref(x, wqkv, wo):
        B, S, D = x.shape
        H = 16
        Dh = D // H
        qkv = (lambda x, *d: x.permute(*d))((x @ wqkv).reshape(B, S, 3, H, Dh), 2, 0, 3, 1, 4)
        q, k, v = qkv[0], qkv[1], qkv[2]
        scores = torch.einsum("bhqd,bhkd->bhqk", q, k) * (Dh ** -0.5)
        p = _softmax(scores, axis=-1)
        o = torch.einsum("bhqk,bhkd->bhqd", p, v)
        return (lambda x, *d: x.permute(*d))(o, 0, 2, 1, 3).reshape(B, S, D) @ wo

    def _B_ref(x, w_gate, w_up, w_down):
        g = torch.einsum("bsd,df->bsf", x, w_gate)
        u = torch.einsum("bsd,df->bsf", x, w_up)
        h = _gelu(g) * u
        return torch.einsum("bsf,fd->bsd", h, w_down)

    x = A_x
    xn = _layernorm(x, axis=-1)
    return x + _A_ref(xn, A_wqkv, A_wo) + _B_ref(xn, B_w_gate, B_w_up, B_w_down)
```

```asm
; @launch grid=(256,1,1) block=(512,1,1) lds=159808
.amdgcn_target "amdgcn-amd-amdhsa--gfx950"
.text
.globl parallel_sum__mha_block__glu_gated_geglu__prompt_kernel
.p2align 8
.type parallel_sum__mha_block__glu_gated_geglu__prompt_kernel,@function
parallel_sum__mha_block__glu_gated_geglu__prompt_kernel:
    s_cmp_ge_u32 s2, 256
    s_cbranch_scc1 F_exit
    s_load_dwordx4 s[4:7], s[0:1], 0
    s_load_dwordx4 s[8:11], s[0:1], 32
    s_load_dwordx4 s[12:15], s[0:1], 64
    v_lshrrev_b32 v12, 6, v0
    v_and_b32 v1, 63, v0
    v_readfirstlane_b32 s32, v12
    v_lshlrev_b32 v2, 4, v1
    v_lshrrev_b32 v3, 5, v1
    v_mov_b32 v54, 0
    v_mov_b64 v[62:63], 0
    s_getpc_b64 s[20:21]
    s_and_b32 s20, s20, 0xffffff00
    s_and_b32 s21, s21, 0xffff
    s_cmp_lt_u32 s2, 32
    s_cselect_b32 s22, CODE_END - parallel_sum__mha_block__glu_gated_geglu__prompt_kernel, 0
    s_mov_b32 s23, 0x20000
    v_lshlrev_b32 v13, 7, v0
    v_subrev_u32 v13, 40960, v13
    buffer_load_dword v55, v13, s[20:23], 0 offen
    s_and_b32 s42, s2, 7
    s_lshr_b32 s43, s2, 3
    s_add_u32 s43, s43, 28
    s_and_b32 s43, s43, 31
    s_lshr_b32 s33, s42, 1
    s_lshl_b32 s33, s33, 2
    s_and_b32 s44, s43, 3
    s_add_u32 s33, s33, s44
    s_and_b32 s34, s42, 1
    s_lshr_b32 s44, s43, 2
    s_lshl_b32 s44, s44, 1
    s_add_u32 s34, s34, s44
    s_and_b32 s35, s32, 3
    s_lshl_b32 s48, s33, 2
    s_add_u32 s48, s48, s35
    s_mov_b32 s46, 0xffff0000
    s_mov_b32 s41, 7
    v_lshrrev_b32 v16, 3, v1
    v_mul_u32_u24 v52, 896, v16
    v_lshrrev_b32 v13, 4, v1
    v_and_b32 v17, 7, v1
    v_xor_b32 v13, v13, v17
    v_lshl_add_u32 v52, v13, 4, v52
    v_xor_b32 v53, 64, v52
    v_add_u32 v53, 6144, v53
    s_movk_i32 s60, 2048
    s_movk_i32 s61, 14336
    s_movk_i32 s62, 14336
    s_movk_i32 s63, -14208
    s_mul_i32 s36, s48, 28672
    s_lshl_b32 s49, s35, 12
    v_bfe_u32 v13, v1, 4, 1
    v_lshlrev_b32 v13, 2, v13
    v_xor_b32 v13, v13, v17
    v_mul_u32_u24 v9, 3584, v16
    v_lshl_add_u32 v9, v13, 4, v9
    v_add_u32 v10, 27648, v9
    s_lshl_b32 s37, s34, 1
    s_lshr_b32 s42, s35, 1
    s_add_u32 s37, s37, s42
    s_lshl_b32 s37, s37, 7
    s_lshl_b32 s53, s35, 11
    s_add_u32 s39, s53, 98304
    s_lshr_b32 s44, s33, 2
    s_lshl_b32 s44, s44, 1
    s_add_u32 s44, s44, s34
    s_mul_i32 s45, s44, 37
    s_lshr_b32 s45, s45, 8
    s_mul_i32 s45, s45, 7
    s_sub_u32 s44, s44, s45
    s_mul_i32 s45, s44, 229376
    s_add_u32 s37, s37, s45
    s_mov_b32 s52, s37
    v_mul_u32_u24 v13, 43, v1
    v_lshrrev_b32 v13, 9, v13
    v_mul_u32_u24 v11, 2496, v13
    v_add_u32 v11, v11, v2
    v_add_u32 v40, 9984, v11
    s_mul_i32 s38, s34, 192
    s_mul_i32 s42, s35, 21504
    s_add_u32 s38, s38, s42
    s_mul_i32 s42, s44, 172032
    s_add_u32 s38, s38, s42
    s_lshl_b32 s44, s44, 7
    s_mul_i32 s40, s35, 1536
    s_add_u32 s40, s40, 131072
    s_mov_b32 s50, -1
    s_mov_b32 s51, 0xffff
    v_mov_b32 v18, 155648
    v_mov_b64 v[20:21], 0
    v_mov_b64 v[22:23], 0
    ds_write_b128 v18, v[20:23]
    ds_write_b128 v18, v[20:23] offset:16
    ds_write_b128 v18, v[20:23] offset:32
    s_lshr_b32 s42, s32, 2
    s_lshl_b32 s43, s42, 11
    s_add_u32 m0, s49, s43
    s_mul_i32 s43, s42, 14336
    s_add_u32 s43, s43, s36
    s_add_u32 s43, s43, s44
    s_lshl_b32 s42, s42, 7
    s_sub_u32 s44, s44, s42
    s_add_u32 s44, s44, 256
    s_cmp_ge_u32 s44, 896
    s_cselect_b32 s42, 896, 0
    s_sub_u32 s44, s44, s42
    s_add_u32 s36, s36, s44
    s_mov_b32 s19, 0x20000
    s_mov_b32 s23, 0x20000
    s_mov_b32 s27, 0x20000
    s_mov_b32 s31, 0x20000
    s_mov_b32 s59, 0x20000
    s_mov_b32 s18, 1835008
    s_mov_b32 s22, 1204224
    s_mov_b32 s26, 1605632
    s_mov_b32 s30, 18874368
    s_movk_i32 s58, 256
    s_waitcnt lgkmcnt(0)
    s_mov_b32 s16, s4
    s_and_b32 s17, s5, 0xffff
    s_cmp_ge_u32 s34, 14
    s_cbranch_scc1 P1_c2
    buffer_load_dwordx4 v52, s[16:19], s43 offen lds
    buffer_load_dwordx4 v53, s[16:19], s43 offen offset:1024 lds
P1_c2:
    s_mov_b32 s20, s6
    s_and_b32 s21, s7, 0xffff
    s_bitcmp1_b32 s32, 0
    s_cselect_b32 s24, s10, s8
    s_cselect_b32 s25, s11, s9
    s_and_b32 s25, s25, 0xffff
    s_mov_b32 s56, s12
    s_and_b32 s57, s13, 0xffff
    s_mov_b32 s28, s14
    s_and_b32 s29, s15, 0xffff
    s_cmp_ge_u32 s34, 14
    s_cbranch_scc1 P1_help
    s_cmp_lt_u32 s32, 4
    s_cbranch_scc1 P1_A
    s_add_u32 m0, s39, 0
    s_nop 0
    buffer_load_dwordx4 v9, s[24:27], s37 offen lds
    buffer_load_dwordx4 v10, s[24:27], s37 offen offset:1024 lds
    s_add_u32 s37, s37, 57344
    s_cmp_ge_u32 s37, 1605632
    s_cselect_b32 s13, 1605632, 0
    s_sub_u32 s37, s37, s13
    s_branch P1_B
P1_A:
    s_add_u32 s37, s37, 57344
    s_mov_b32 s12, s44
    s_add_u32 s12, s12, 128
    s_cmp_eq_u32 s12, 896
    s_cselect_b32 s12, 0, s12
    s_cselect_b32 s43, 896, 0
    s_sub_u32 s63, 4294953088, s43
    s_add_u32 s49, s49, 32768
    s_add_u32 m0, s40, 0
    s_mov_b64 exec, s[50:51]
    buffer_load_dwordx4 v11, s[20:23], s38 offen lds
    s_mov_b64 exec, -1
    s_mov_b64 exec, s[50:51]
    buffer_load_dwordx4 v40, s[20:23], s38 offen offset:768 lds
    s_mov_b64 exec, -1
    s_add_u32 s38, s38, 86016
    s_cmp_ge_u32 s38, 1204224
    s_cselect_b32 s13, 1204224, 0
    s_sub_u32 s38, s38, s13
    s_mov_b32 s54, 16384
    s_mov_b32 s55, 12288
    v_and_b32 v13, 31, v1
    v_bfe_u32 v14, v1, 1, 3
    v_xor_b32 v14, v14, v3
    v_lshlrev_b32 v14, 4, v14
    v_lshl_add_u32 v48, v13, 7, v14
    s_lshl_b32 s42, s35, 12
    v_add_u32 v48, s42, v48
    v_xor_b32 v49, 32, v48
    v_xor_b32 v50, 64, v48
    v_xor_b32 v51, 96, v48
    v_and_b32 v12, 15, v1
    v_lshrrev_b32 v13, 2, v12
    v_lshl_add_u32 v14, v3, 3, v13
    v_bfe_u32 v13, v1, 4, 1
    v_lshlrev_b32 v15, 5, v13
    v_and_b32 v13, 3, v12
    v_lshl_add_u32 v15, v13, 3, v15
    s_mov_b32 s47, 16384
    v_mul_u32_u24 v7, 192, v14
    v_add_u32 v7, v7, v15
    v_add_u32 v7, 131072, v7
    v_mfma_f32_32x32x16_bf16 v[128:143], v[20:23], v[20:23], 0
    v_mfma_f32_32x32x16_bf16 v[144:159], v[20:23], v[20:23], 0
    v_mfma_f32_32x32x16_bf16 v[160:175], v[20:23], v[20:23], 0
    s_lshl_b32 s45, s48, 12
    s_mul_i32 s42, s34, 12
    v_add_u32 v16, s42, v1
    v_mul_u32_u24 v17, 9363, v16
    v_lshrrev_b32 v17, 16, v17
    v_mul_u32_u24 v18, 7, v17
    v_sub_u32 v18, v16, v18
    v_and_b32 v19, 7, v17
    v_lshl_add_u32 v20, v19, 19, s45
    v_bfe_u32 v19, v17, 3, 1
    v_xor_b32 v19, 1, v19
    v_lshl_add_u32 v20, v19, 11, v20
    v_add_u32 v21, 263680, v20
    v_lshrrev_b32 v19, 2, v18
    v_lshl_add_u32 v20, v19, 18, v20
    v_and_b32 v19, 3, v18
    v_lshl_add_u32 v20, v19, 9, v20
    v_cmp_eq_u32 vcc, 3, v18
    v_lshlrev_b32 v19, 2, v3
    v_bfrev_b32 v17, 1
    v_cndmask_b32 v21, v17, v21, vcc
    ds_bpermute_b32 v28, v19, v20 offset:0
    ds_bpermute_b32 v34, v19, v21 offset:0
    ds_bpermute_b32 v29, v19, v20 offset:8
    ds_bpermute_b32 v35, v19, v21 offset:8
    ds_bpermute_b32 v30, v19, v20 offset:16
    ds_bpermute_b32 v36, v19, v21 offset:16
    ds_bpermute_b32 v31, v19, v20 offset:24
    ds_bpermute_b32 v37, v19, v21 offset:24
    ds_bpermute_b32 v32, v19, v20 offset:32
    ds_bpermute_b32 v38, v19, v21 offset:32
    ds_bpermute_b32 v33, v19, v20 offset:40
    ds_bpermute_b32 v39, v19, v21 offset:40
    v_and_b32 v19, 0x1f0, v2
    v_mul_u32_u24 v24, 7168, v3
    v_add_u32 v24, v24, v19
    s_waitcnt lgkmcnt(0)
    v_add_u32 v28, v28, v19
    v_add_u32 v29, v29, v19
    v_add_u32 v30, v30, v19
    v_add_u32 v31, v31, v19
    v_add_u32 v32, v32, v19
    v_add_u32 v33, v33, v19
    v_add_u32 v34, v34, v19
    v_add_u32 v35, v35, v19
    v_add_u32 v36, v36, v19
    v_add_u32 v37, v37, v19
    v_add_u32 v38, v38, v19
    v_add_u32 v39, v39, v19
    s_add_u32 m0, s40, 6144
    s_mov_b64 exec, s[50:51]
    buffer_load_dwordx4 v11, s[20:23], s38 offen lds
    s_mov_b64 exec, -1
    s_mov_b64 exec, s[50:51]
    buffer_load_dwordx4 v40, s[20:23], s38 offen offset:768 lds
    s_mov_b64 exec, -1
    s_add_u32 s38, s38, 86016
    s_cmp_ge_u32 s38, 1204224
    s_cselect_b32 s13, 1204224, 0
    s_sub_u32 s38, s38, s13
    s_add_u32 m0, s39, 8192
    s_nop 0
    buffer_load_dwordx4 v9, s[24:27], s37 offen lds
    buffer_load_dwordx4 v10, s[24:27], s37 offen offset:1024 lds
    s_add_u32 s37, s37, 57344
    s_cmp_ge_u32 s37, 1605632
    s_cselect_b32 s13, 1605632, 0
    s_sub_u32 s37, s37, s13
    s_waitcnt vmcnt(4)
    s_barrier
    ds_read_b128 v[112:115], v48
    ds_read_b128 v[116:119], v49
    ds_read_b64_tr_b16 v[64:65], v7 offset:0
    ds_read_b64_tr_b16 v[66:67], v7 offset:768
    ds_read_b64_tr_b16 v[68:69], v7 offset:64
    ds_read_b64_tr_b16 v[70:71], v7 offset:832
    ds_read_b64_tr_b16 v[72:73], v7 offset:128
    ds_read_b64_tr_b16 v[74:75], v7 offset:896
    ds_read_b64_tr_b16 v[76:77], v7 offset:3072
    ds_read_b64_tr_b16 v[78:79], v7 offset:3840
    ds_read_b64_tr_b16 v[80:81], v7 offset:3136
    ds_read_b64_tr_b16 v[82:83], v7 offset:3904
    ds_read_b64_tr_b16 v[84:85], v7 offset:3200
    ds_read_b64_tr_b16 v[86:87], v7 offset:3968
    s_add_u32 m0, s40, 12288
    s_mov_b64 exec, s[50:51]
    buffer_load_dwordx4 v11, s[20:23], s38 offen lds
    s_mov_b64 exec, -1
    s_mov_b64 exec, s[50:51]
    buffer_load_dwordx4 v40, s[20:23], s38 offen offset:768 lds
    s_mov_b64 exec, -1
    s_add_u32 s38, s38, 86016
    s_cmp_ge_u32 s38, 1204224
    s_cselect_b32 s13, 1204224, 0
    s_sub_u32 s38, s38, s13
    s_add_u32 m0, s39, 16384
    s_nop 0
    buffer_load_dwordx4 v9, s[24:27], s37 offen lds
    buffer_load_dwordx4 v10, s[24:27], s37 offen offset:1024 lds
    s_add_u32 s37, s37, 57344
    s_cmp_ge_u32 s37, 1605632
    s_cselect_b32 s13, 1605632, 0
    s_sub_u32 s37, s37, s13
    s_mov_b32 m0, s49
    s_add_u32 s49, s49, s60
    buffer_load_dwordx4 v52, s[16:19], s36 offen lds
    buffer_load_dwordx4 v53, s[16:19], s36 offen offset:1024 lds
    s_add_u32 s36, s36, s62
    s_add_u32 m0, s40, 18432
    s_mov_b64 exec, s[50:51]
    buffer_load_dwordx4 v11, s[20:23], s38 offen lds
    s_mov_b64 exec, -1
    s_mov_b64 exec, s[50:51]
    buffer_load_dwordx4 v40, s[20:23], s38 offen offset:768 lds
    s_mov_b64 exec, -1
    s_add_u32 s38, s38, 86016
    s_cmp_ge_u32 s38, 1204224
    s_cselect_b32 s13, 1204224, 0
    s_sub_u32 s38, s38, s13
    s_add_u32 m0, s39, 24576
    s_nop 0
    buffer_load_dwordx4 v9, s[24:27], s37 offen lds
    buffer_load_dwordx4 v10, s[24:27], s37 offen offset:1024 lds
    s_add_u32 s37, s37, 57344
    s_cmp_ge_u32 s37, 1605632
    s_cselect_b32 s13, 1605632, 0
    s_sub_u32 s37, s37, s13
    s_mov_b32 m0, s49
    s_add_u32 s49, s49, s61
    buffer_load_dwordx4 v52, s[16:19], s36 offen lds
    buffer_load_dwordx4 v53, s[16:19], s36 offen offset:1024 lds
    s_add_u32 s36, s36, s63
    s_cmp_gt_u32 s34, 9
    s_cbranch_scc1 P1_loopA_VVV
    s_cmp_eq_u32 s34, 9
    s_cbranch_scc1 P1_loopA_QVV
P1_loopA_QQQ:
    s_waitcnt vmcnt(12) lgkmcnt(0)
    s_barrier
    s_cmp_gt_u32 s41, 4
    s_cbranch_scc1 P1_loopA_QQQ_n0
    s_getpc_b64 s[44:45]
    s_branch P1_side
P1_loopA_QQQ_n0:
    s_add_u32 m0, s39, 0
    s_nop 0
    buffer_load_dwordx4 v9, s[24:27], s37 offen lds
    ds_read_b128 v[120:123], v50
    ds_read_b64_tr_b16 v[88:89], v7 offset:6144
    ds_read_b64_tr_b16 v[90:91], v7 offset:6912
    v_mfma_f32_32x32x16_bf16 v[128:143], v[64:67], v[112:115], v[128:143]
    buffer_load_dwordx4 v10, s[24:27], s37 offen offset:1024 lds
    s_add_u32 s37, s37, 57344
    s_cmp_ge_u32 s37, 1605632
    s_cselect_b32 s13, 1605632, 0
    s_sub_u32 s37, s37, s13
    ds_read_b64_tr_b16 v[92:93], v7 offset:6208
    ds_read_b64_tr_b16 v[94:95], v7 offset:6976
    ds_read_b64_tr_b16 v[96:97], v7 offset:6272
    v_mfma_f32_32x32x16_bf16 v[144:159], v[68:71], v[112:115], v[144:159]
    s_add_u32 m0, s40, 0
    s_mov_b64 exec, s[50:51]
    buffer_load_dwordx4 v11, s[20:23], s38 offen lds
    s_mov_b64 exec, -1
    ds_read_b64_tr_b16 v[98:99], v7 offset:7040
    ds_read_b128 v[124:127], v51
    ds_read_b64_tr_b16 v[100:101], v7 offset:9216
    v_mfma_f32_32x32x16_bf16 v[160:175], v[72:75], v[112:115], v[160:175]
    s_mov_b64 exec, s[50:51]
    buffer_load_dwordx4 v40, s[20:23], s38 offen offset:768 lds
    s_mov_b64 exec, -1
    s_add_u32 s38, s38, 86016
    s_cmp_ge_u32 s38, 1204224
    s_cselect_b32 s13, 1204224, 0
    s_sub_u32 s38, s38, s13
    ds_read_b64_tr_b16 v[102:103], v7 offset:9984
    ds_read_b64_tr_b16 v[104:105], v7 offset:9280
    ds_read_b64_tr_b16 v[106:107], v7 offset:10048
    v_mfma_f32_32x32x16_bf16 v[128:143], v[76:79], v[116:119], v[128:143]
    s_mov_b32 m0, s49
    s_add_u32 s49, s49, s60
    buffer_load_dwordx4 v52, s[16:19], s36 offen lds
    ds_read_b64_tr_b16 v[108:109], v7 offset:9344
    ds_read_b64_tr_b16 v[110:111], v7 offset:10112
    v_mfma_f32_32x32x16_bf16 v[144:159], v[80:83], v[116:119], v[144:159]
    buffer_load_dwordx4 v53, s[16:19], s36 offen offset:1024 lds
    s_add_u32 s36, s36, s62
    s_cmp_eq_u32 s41, 2
    s_cselect_b32 s43, 4294885376, s54
    v_add_u32 v48, s43, v48
    v_add_u32 v49, s43, v49
    v_add_u32 v50, s43, v50
    v_add_u32 v51, s43, v51
    v_add_u32 v7, s55, v7
    s_add_u32 s12, s12, 128
    s_cmp_eq_u32 s12, 896
    s_cselect_b32 s12, 0, s12
    s_cselect_b32 s43, 896, 0
    s_sub_u32 s63, 4294953088, s43
    v_mfma_f32_32x32x16_bf16 v[160:175], v[84:87], v[116:119], v[160:175]
    s_waitcnt vmcnt(12) lgkmcnt(0)
    s_barrier
    s_add_u32 m0, s39, 8192
    s_nop 0
    buffer_load_dwordx4 v9, s[24:27], s37 offen lds
    ds_read_b128 v[112:115], v48
    ds_read_b64_tr_b16 v[64:65], v7 offset:0
    ds_read_b64_tr_b16 v[66:67], v7 offset:768
    v_mfma_f32_32x32x16_bf16 v[128:143], v[88:91], v[120:123], v[128:143]
    buffer_load_dwordx4 v10, s[24:27], s37 offen offset:1024 lds
    s_add_u32 s37, s37, 57344
    s_cmp_ge_u32 s37, 1605632
    s_cselect_b32 s13, 1605632, 0
    s_sub_u32 s37, s37, s13
    ds_read_b64_tr_b16 v[68:69], v7 offset:64
    ds_read_b64_tr_b16 v[70:71], v7 offset:832
    ds_read_b64_tr_b16 v[72:73], v7 offset:128
    v_mfma_f32_32x32x16_bf16 v[144:159], v[92:95], v[120:123], v[144:159]
    s_add_u32 m0, s40, 6144
    s_mov_b64 exec, s[50:51]
    buffer_load_dwordx4 v11, s[20:23], s38 offen lds
    s_mov_b64 exec, -1
    ds_read_b64_tr_b16 v[74:75], v7 offset:896
    ds_read_b128 v[116:119], v49
    ds_read_b64_tr_b16 v[76:77], v7 offset:3072
    v_mfma_f32_32x32x16_bf16 v[160:175], v[96:99], v[120:123], v[160:175]
    s_mov_b64 exec, s[50:51]
    buffer_load_dwordx4 v40, s[20:23], s38 offen offset:768 lds
    s_mov_b64 exec, -1
    s_add_u32 s38, s38, 86016
    s_cmp_ge_u32 s38, 1204224
    s_cselect_b32 s13, 1204224, 0
    s_sub_u32 s38, s38, s13
    ds_read_b64_tr_b16 v[78:79], v7 offset:3840
    ds_read_b64_tr_b16 v[80:81], v7 offset:3136
    ds_read_b64_tr_b16 v[82:83], v7 offset:3904
    v_mfma_f32_32x32x16_bf16 v[128:143], v[100:103], v[124:127], v[128:143]
    s_mov_b32 m0, s49
    s_add_u32 s49, s49, s61
    buffer_load_dwordx4 v52, s[16:19], s36 offen lds
    ds_read_b64_tr_b16 v[84:85], v7 offset:3200
    ds_read_b64_tr_b16 v[86:87], v7 offset:3968
    v_mfma_f32_32x32x16_bf16 v[144:159], v[104:107], v[124:127], v[144:159]
    buffer_load_dwordx4 v53, s[16:19], s36 offen offset:1024 lds
    s_add_u32 s36, s36, s63
    s_add_u32 s39, s39, s47
    s_add_u32 s40, s40, s55
    s_sub_u32 s47, 0, s47
    s_sub_u32 s55, 0, s55
    s_sub_u32 s41, s41, 1
    s_cmp_lg_u32 s41, 0
    v_mfma_f32_32x32x16_bf16 v[160:175], v[108:111], v[124:127], v[160:175]
    s_cbranch_scc1 P1_loopA_QQQ
    s_getpc_b64 s[44:45]
    s_branch P1_auxA
    v_mfma_f32_32x32x16_bf16 v[128:143], v[176:179], v[188:191], v[128:143]
    v_mfma_f32_32x32x16_bf16 v[144:159], v[180:183], v[188:191], v[144:159]
    v_mfma_f32_32x32x16_bf16 v[160:175], v[184:187], v[188:191], v[160:175]
    s_branch P1_Aepi
P1_loopA_QVV:
    s_waitcnt vmcnt(12) lgkmcnt(0)
    s_barrier
    s_cmp_gt_u32 s41, 4
    s_cbranch_scc1 P1_loopA_QVV_n0
    s_getpc_b64 s[44:45]
    s_branch P1_side
P1_loopA_QVV_n0:
    s_add_u32 m0, s39, 0
    s_nop 0
    buffer_load_dwordx4 v9, s[24:27], s37 offen lds
    ds_read_b128 v[120:123], v50
    ds_read_b64_tr_b16 v[88:89], v7 offset:6144
    ds_read_b64_tr_b16 v[90:91], v7 offset:6912
    v_mfma_f32_32x32x16_bf16 v[128:143], v[64:67], v[112:115], v[128:143]
    buffer_load_dwordx4 v10, s[24:27], s37 offen offset:1024 lds
    s_add_u32 s37, s37, 57344
    s_cmp_ge_u32 s37, 1605632
    s_cselect_b32 s13, 1605632, 0
    s_sub_u32 s37, s37, s13
    ds_read_b64_tr_b16 v[92:93], v7 offset:6208
    ds_read_b64_tr_b16 v[94:95], v7 offset:6976
    ds_read_b64_tr_b16 v[96:97], v7 offset:6272
    v_mfma_f32_32x32x16_bf16 v[144:159], v[112:115], v[68:71], v[144:159]
    s_add_u32 m0, s40, 0
    s_mov_b64 exec, s[50:51]
    buffer_load_dwordx4 v11, s[20:23], s38 offen lds
    s_mov_b64 exec, -1
    ds_read_b64_tr_b16 v[98:99], v7 offset:7040
    ds_read_b128 v[124:127], v51
    ds_read_b64_tr_b16 v[100:101], v7 offset:9216
    v_mfma_f32_32x32x16_bf16 v[160:175], v[112:115], v[72:75], v[160:175]
    s_mov_b64 exec, s[50:51]
    buffer_load_dwordx4 v40, s[20:23], s38 offen offset:768 lds
    s_mov_b64 exec, -1
    s_add_u32 s38, s38, 86016
    s_cmp_ge_u32 s38, 1204224
    s_cselect_b32 s13, 1204224, 0
    s_sub_u32 s38, s38, s13
    ds_read_b64_tr_b16 v[102:103], v7 offset:9984
    ds_read_b64_tr_b16 v[104:105], v7 offset:9280
    ds_read_b64_tr_b16 v[106:107], v7 offset:10048
    v_mfma_f32_32x32x16_bf16 v[128:143], v[76:79], v[116:119], v[128:143]
    s_mov_b32 m0, s49
    s_add_u32 s49, s49, s60
    buffer_load_dwordx4 v52, s[16:19], s36 offen lds
    ds_read_b64_tr_b16 v[108:109], v7 offset:9344
    ds_read_b64_tr_b16 v[110:111], v7 offset:10112
    v_mfma_f32_32x32x16_bf16 v[144:159], v[116:119], v[80:83], v[144:159]
    buffer_load_dwordx4 v53, s[16:19], s36 offen offset:1024 lds
    s_add_u32 s36, s36, s62
    s_cmp_eq_u32 s41, 2
    s_cselect_b32 s43, 4294885376, s54
    v_add_u32 v48, s43, v48
    v_add_u32 v49, s43, v49
    v_add_u32 v50, s43, v50
    v_add_u32 v51, s43, v51
    v_add_u32 v7, s55, v7
    s_add_u32 s12, s12, 128
    s_cmp_eq_u32 s12, 896
    s_cselect_b32 s12, 0, s12
    s_cselect_b32 s43, 896, 0
    s_sub_u32 s63, 4294953088, s43
    v_mfma_f32_32x32x16_bf16 v[160:175], v[116:119], v[84:87], v[160:175]
    s_waitcnt vmcnt(12) lgkmcnt(0)
    s_barrier
    s_add_u32 m0, s39, 8192
    s_nop 0
    buffer_load_dwordx4 v9, s[24:27], s37 offen lds
    ds_read_b128 v[112:115], v48
    ds_read_b64_tr_b16 v[64:65], v7 offset:0
    ds_read_b64_tr_b16 v[66:67], v7 offset:768
    v_mfma_f32_32x32x16_bf16 v[128:143], v[88:91], v[120:123], v[128:143]
    buffer_load_dwordx4 v10, s[24:27], s37 offen offset:1024 lds
    s_add_u32 s37, s37, 57344
    s_cmp_ge_u32 s37, 1605632
    s_cselect_b32 s13, 1605632, 0
    s_sub_u32 s37, s37, s13
    ds_read_b64_tr_b16 v[68:69], v7 offset:64
    ds_read_b64_tr_b16 v[70:71], v7 offset:832
    ds_read_b64_tr_b16 v[72:73], v7 offset:128
    v_mfma_f32_32x32x16_bf16 v[144:159], v[120:123], v[92:95], v[144:159]
    s_add_u32 m0, s40, 6144
    s_mov_b64 exec, s[50:51]
    buffer_load_dwordx4 v11, s[20:23], s38 offen lds
    s_mov_b64 exec, -1
    ds_read_b64_tr_b16 v[74:75], v7 offset:896
    ds_read_b128 v[116:119], v49
    ds_read_b64_tr_b16 v[76:77], v7 offset:3072
    v_mfma_f32_32x32x16_bf16 v[160:175], v[120:123], v[96:99], v[160:175]
    s_mov_b64 exec, s[50:51]
    buffer_load_dwordx4 v40, s[20:23], s38 offen offset:768 lds
    s_mov_b64 exec, -1
    s_add_u32 s38, s38, 86016
    s_cmp_ge_u32 s38, 1204224
    s_cselect_b32 s13, 1204224, 0
    s_sub_u32 s38, s38, s13
    ds_read_b64_tr_b16 v[78:79], v7 offset:3840
    ds_read_b64_tr_b16 v[80:81], v7 offset:3136
    ds_read_b64_tr_b16 v[82:83], v7 offset:3904
    v_mfma_f32_32x32x16_bf16 v[128:143], v[100:103], v[124:127], v[128:143]
    s_mov_b32 m0, s49
    s_add_u32 s49, s49, s61
    buffer_load_dwordx4 v52, s[16:19], s36 offen lds
    ds_read_b64_tr_b16 v[84:85], v7 offset:3200
    ds_read_b64_tr_b16 v[86:87], v7 offset:3968
    v_mfma_f32_32x32x16_bf16 v[144:159], v[124:127], v[104:107], v[144:159]
    buffer_load_dwordx4 v53, s[16:19], s36 offen offset:1024 lds
    s_add_u32 s36, s36, s63
    s_add_u32 s39, s39, s47
    s_add_u32 s40, s40, s55
    s_sub_u32 s47, 0, s47
    s_sub_u32 s55, 0, s55
    s_sub_u32 s41, s41, 1
    s_cmp_lg_u32 s41, 0
    v_mfma_f32_32x32x16_bf16 v[160:175], v[124:127], v[108:111], v[160:175]
    s_cbranch_scc1 P1_loopA_QVV
    s_getpc_b64 s[44:45]
    s_branch P1_auxA
    v_mfma_f32_32x32x16_bf16 v[128:143], v[176:179], v[188:191], v[128:143]
    v_mfma_f32_32x32x16_bf16 v[144:159], v[188:191], v[180:183], v[144:159]
    v_mfma_f32_32x32x16_bf16 v[160:175], v[188:191], v[184:187], v[160:175]
    s_branch P1_Aepi
P1_loopA_VVV:
    s_waitcnt vmcnt(12) lgkmcnt(0)
    s_barrier
    s_cmp_gt_u32 s41, 4
    s_cbranch_scc1 P1_loopA_VVV_n0
    s_getpc_b64 s[44:45]
    s_branch P1_side
P1_loopA_VVV_n0:
    s_add_u32 m0, s39, 0
    s_nop 0
    buffer_load_dwordx4 v9, s[24:27], s37 offen lds
    ds_read_b128 v[120:123], v50
    ds_read_b64_tr_b16 v[88:89], v7 offset:6144
    ds_read_b64_tr_b16 v[90:91], v7 offset:6912
    v_mfma_f32_32x32x16_bf16 v[128:143], v[112:115], v[64:67], v[128:143]
    buffer_load_dwordx4 v10, s[24:27], s37 offen offset:1024 lds
    s_add_u32 s37, s37, 57344
    s_cmp_ge_u32 s37, 1605632
    s_cselect_b32 s13, 1605632, 0
    s_sub_u32 s37, s37, s13
    ds_read_b64_tr_b16 v[92:93], v7 offset:6208
    ds_read_b64_tr_b16 v[94:95], v7 offset:6976
    ds_read_b64_tr_b16 v[96:97], v7 offset:6272
    v_mfma_f32_32x32x16_bf16 v[144:159], v[112:115], v[68:71], v[144:159]
    s_add_u32 m0, s40, 0
    s_mov_b64 exec, s[50:51]
    buffer_load_dwordx4 v11, s[20:23], s38 offen lds
    s_mov_b64 exec, -1
    ds_read_b64_tr_b16 v[98:99], v7 offset:7040
    ds_read_b128 v[124:127], v51
    ds_read_b64_tr_b16 v[100:101], v7 offset:9216
    v_mfma_f32_32x32x16_bf16 v[160:175], v[112:115], v[72:75], v[160:175]
    s_mov_b64 exec, s[50:51]
    buffer_load_dwordx4 v40, s[20:23], s38 offen offset:768 lds
    s_mov_b64 exec, -1
    s_add_u32 s38, s38, 86016
    s_cmp_ge_u32 s38, 1204224
    s_cselect_b32 s13, 1204224, 0
    s_sub_u32 s38, s38, s13
    ds_read_b64_tr_b16 v[102:103], v7 offset:9984
    ds_read_b64_tr_b16 v[104:105], v7 offset:9280
    ds_read_b64_tr_b16 v[106:107], v7 offset:10048
    v_mfma_f32_32x32x16_bf16 v[128:143], v[116:119], v[76:79], v[128:143]
    s_mov_b32 m0, s49
    s_add_u32 s49, s49, s60
    buffer_load_dwordx4 v52, s[16:19], s36 offen lds
    ds_read_b64_tr_b16 v[108:109], v7 offset:9344
    ds_read_b64_tr_b16 v[110:111], v7 offset:10112
    v_mfma_f32_32x32x16_bf16 v[144:159], v[116:119], v[80:83], v[144:159]
    buffer_load_dwordx4 v53, s[16:19], s36 offen offset:1024 lds
    s_add_u32 s36, s36, s62
    s_cmp_eq_u32 s41, 2
    s_cselect_b32 s43, 4294885376, s54
    v_add_u32 v48, s43, v48
    v_add_u32 v49, s43, v49
    v_add_u32 v50, s43, v50
    v_add_u32 v51, s43, v51
    v_add_u32 v7, s55, v7
    s_add_u32 s12, s12, 128
    s_cmp_eq_u32 s12, 896
    s_cselect_b32 s12, 0, s12
    s_cselect_b32 s43, 896, 0
    s_sub_u32 s63, 4294953088, s43
    v_mfma_f32_32x32x16_bf16 v[160:175], v[116:119], v[84:87], v[160:175]
    s_waitcnt vmcnt(12) lgkmcnt(0)
    s_barrier
    s_add_u32 m0, s39, 8192
    s_nop 0
    buffer_load_dwordx4 v9, s[24:27], s37 offen lds
    ds_read_b128 v[112:115], v48
    ds_read_b64_tr_b16 v[64:65], v7 offset:0
    ds_read_b64_tr_b16 v[66:67], v7 offset:768
    v_mfma_f32_32x32x16_bf16 v[128:143], v[120:123], v[88:91], v[128:143]
    buffer_load_dwordx4 v10, s[24:27], s37 offen offset:1024 lds
    s_add_u32 s37, s37, 57344
    s_cmp_ge_u32 s37, 1605632
    s_cselect_b32 s13, 1605632, 0
    s_sub_u32 s37, s37, s13
    ds_read_b64_tr_b16 v[68:69], v7 offset:64
    ds_read_b64_tr_b16 v[70:71], v7 offset:832
    ds_read_b64_tr_b16 v[72:73], v7 offset:128
    v_mfma_f32_32x32x16_bf16 v[144:159], v[120:123], v[92:95], v[144:159]
    s_add_u32 m0, s40, 6144
    s_mov_b64 exec, s[50:51]
    buffer_load_dwordx4 v11, s[20:23], s38 offen lds
    s_mov_b64 exec, -1
    ds_read_b64_tr_b16 v[74:75], v7 offset:896
    ds_read_b128 v[116:119], v49
    ds_read_b64_tr_b16 v[76:77], v7 offset:3072
    v_mfma_f32_32x32x16_bf16 v[160:175], v[120:123], v[96:99], v[160:175]
    s_mov_b64 exec, s[50:51]
    buffer_load_dwordx4 v40, s[20:23], s38 offen offset:768 lds
    s_mov_b64 exec, -1
    s_add_u32 s38, s38, 86016
    s_cmp_ge_u32 s38, 1204224
    s_cselect_b32 s13, 1204224, 0
    s_sub_u32 s38, s38, s13
    ds_read_b64_tr_b16 v[78:79], v7 offset:3840
    ds_read_b64_tr_b16 v[80:81], v7 offset:3136
    ds_read_b64_tr_b16 v[82:83], v7 offset:3904
    v_mfma_f32_32x32x16_bf16 v[128:143], v[124:127], v[100:103], v[128:143]
    s_mov_b32 m0, s49
    s_add_u32 s49, s49, s61
    buffer_load_dwordx4 v52, s[16:19], s36 offen lds
    ds_read_b64_tr_b16 v[84:85], v7 offset:3200
    ds_read_b64_tr_b16 v[86:87], v7 offset:3968
    v_mfma_f32_32x32x16_bf16 v[144:159], v[124:127], v[104:107], v[144:159]
    buffer_load_dwordx4 v53, s[16:19], s36 offen offset:1024 lds
    s_add_u32 s36, s36, s63
    s_add_u32 s39, s39, s47
    s_add_u32 s40, s40, s55
    s_sub_u32 s47, 0, s47
    s_sub_u32 s55, 0, s55
    s_sub_u32 s41, s41, 1
    s_cmp_lg_u32 s41, 0
    v_mfma_f32_32x32x16_bf16 v[160:175], v[124:127], v[108:111], v[160:175]
    s_cbranch_scc1 P1_loopA_VVV
    s_getpc_b64 s[44:45]
    s_branch P1_auxA
    v_mfma_f32_32x32x16_bf16 v[128:143], v[188:191], v[176:179], v[128:143]
    v_mfma_f32_32x32x16_bf16 v[144:159], v[188:191], v[180:183], v[144:159]
    v_mfma_f32_32x32x16_bf16 v[160:175], v[188:191], v[184:187], v[160:175]
P1_Aepi:
    s_mul_i32 s42, s34, 3
    s_cmp_lt_u32 s42, 14
    s_cselect_b32 s43, 0x3e8b97f6, 1.0
    v_mul_f32 v18, s43, v4
    v_mul_f32 v19, s43, v4
    s_cmp_lt_u32 s42, 13
    s_cselect_b32 s43, 0x3e8b97f6, 1.0
    v_mul_f32 v20, s43, v4
    v_mul_f32 v21, s43, v4
    s_cmp_lt_u32 s42, 12
    s_cselect_b32 s43, 0x3e8b97f6, 1.0
    v_mul_f32 v22, s43, v4
    v_mul_f32 v23, s43, v4
    v_mov_b32 v16, 0x3f803f80
    v_mov_b32 v17, 0x00003f80
    s_mul_i32 s44, s48, 28672
    s_lshl_b32 s45, s42, 9
    s_add_u32 s44, s44, s45
    s_add_u32 s44, s44, 4179968
    s_add_u32 s45, s44, 14336
    s_cmp_ge_u32 s42, 28
    s_cbranch_scc1 P1_eV0
    v_pk_mul_f32 v[128:129], v[128:129], v[18:19]
    v_pk_mul_f32 v[130:131], v[130:131], v[18:19]
    v_pk_mul_f32 v[132:133], v[132:133], v[18:19]
    v_pk_mul_f32 v[134:135], v[134:135], v[18:19]
    v_pk_mul_f32 v[136:137], v[136:137], v[18:19]
    v_pk_mul_f32 v[138:139], v[138:139], v[18:19]
    v_pk_mul_f32 v[140:141], v[140:141], v[18:19]
    v_pk_mul_f32 v[142:143], v[142:143], v[18:19]
    v_cvt_pk_bf16_f32 v64, v128, v129
    v_cvt_pk_bf16_f32 v65, v130, v131
    v_cvt_pk_bf16_f32 v66, v132, v133
    v_cvt_pk_bf16_f32 v67, v134, v135
    v_cvt_pk_bf16_f32 v70, v136, v137
    v_cvt_pk_bf16_f32 v71, v138, v139
    v_cvt_pk_bf16_f32 v72, v140, v141
    v_cvt_pk_bf16_f32 v73, v142, v143
    v_mov_b64 v[68:69], v[16:17]
    v_cmp_gt_i32 s[4:5], 0, v34
    v_mov_b64 v[74:75], v[16:17]
    v_cmp_gt_i32 s[6:7], 0, v35
    v_permlane32_swap_b32 v64, v66
    v_permlane32_swap_b32 v65, v67
    v_permlane32_swap_b32 v70, v72
    v_permlane32_swap_b32 v71, v73
    s_waitcnt vmcnt(4)
    s_barrier
    s_add_u32 s49, s53, 49152
    s_add_u32 s36, s52, 1261568
    s_cmp_ge_u32 s36, 1605632
    s_cselect_b32 s13, 1605632, 0
    s_sub_u32 s36, s36, s13
    s_mov_b32 m0, s49
    s_add_u32 s49, s49, s60
    buffer_load_dwordx4 v52, s[16:19], s36 offen lds
    buffer_load_dwordx4 v53, s[16:19], s36 offen offset:1024 lds
    s_add_u32 s36, s36, s62
    s_mov_b32 m0, s49
    s_add_u32 s49, s49, s61
    buffer_load_dwordx4 v52, s[16:19], s36 offen lds
    buffer_load_dwordx4 v53, s[16:19], s36 offen offset:1024 lds
    s_add_u32 s36, s36, s63
    s_add_u32 s49, s53, 114688
    s_add_u32 s36, s52, 1490944
    s_cmp_ge_u32 s36, 1605632
    s_cselect_b32 s13, 1605632, 0
    s_sub_u32 s36, s36, s13
    s_mov_b32 m0, s49
    s_add_u32 s49, s49, s60
    buffer_load_dwordx4 v52, s[16:19], s36 offen lds
    buffer_load_dwordx4 v53, s[16:19], s36 offen offset:1024 lds
    s_add_u32 s36, s36, s62
    s_mov_b32 m0, s49
    s_add_u32 s49, s49, s61
    buffer_load_dwordx4 v52, s[16:19], s36 offen lds
    buffer_load_dwordx4 v53, s[16:19], s36 offen offset:1024 lds
    s_add_u32 s36, s36, s63
    s_cmp_eq_u64 s[4:5], -1
    s_cbranch_scc1 P1_eS00
    buffer_store_dwordx4 v[66:69], v34, s[28:31], 0 offen sc1
    s_not_b64 exec, s[4:5]
    s_nop 0
    v_mov_b64 v[66:67], v[16:17]
    s_mov_b64 exec, -1
P1_eS00:
    buffer_store_dwordx4 v[64:67], v28, s[28:31], 0 offen sc1
    s_cmp_eq_u64 s[6:7], -1
    s_cbranch_scc1 P1_eS01
    buffer_store_dwordx4 v[72:75], v35, s[28:31], 0 offen sc1
    s_not_b64 exec, s[6:7]
    s_nop 0
    v_mov_b64 v[72:73], v[16:17]
    s_mov_b64 exec, -1
P1_eS01:
    buffer_store_dwordx4 v[70:73], v29, s[28:31], 0 offen sc1
    s_branch P1_eN0
P1_eV0:
    v_pk_mul_f32 v[128:129], v[128:129], v[192:193]
    v_pk_mul_f32 v[130:131], v[130:131], v[194:195]
    v_pk_mul_f32 v[132:133], v[132:133], v[196:197]
    v_pk_mul_f32 v[134:135], v[134:135], v[198:199]
    v_pk_mul_f32 v[136:137], v[136:137], v[200:201]
    v_pk_mul_f32 v[138:139], v[138:139], v[202:203]
    v_pk_mul_f32 v[140:141], v[140:141], v[204:205]
    v_pk_mul_f32 v[142:143], v[142:143], v[206:207]
    v_cvt_pk_bf16_f32 v64, v128, v129
    v_cvt_pk_bf16_f32 v65, v130, v131
    v_cvt_pk_bf16_f32 v66, v132, v133
    v_cvt_pk_bf16_f32 v67, v134, v135
    v_cvt_pk_bf16_f32 v68, v136, v137
    v_cvt_pk_bf16_f32 v69, v138, v139
    v_cvt_pk_bf16_f32 v70, v140, v141
    v_cvt_pk_bf16_f32 v71, v142, v143
    s_waitcnt vmcnt(4)
    s_barrier
    s_add_u32 s49, s53, 49152
    s_add_u32 s36, s52, 1261568
    s_cmp_ge_u32 s36, 1605632
    s_cselect_b32 s13, 1605632, 0
    s_sub_u32 s36, s36, s13
    s_mov_b32 m0, s49
    s_add_u32 s49, s49, s60
    buffer_load_dwordx4 v52, s[16:19], s36 offen lds
    buffer_load_dwordx4 v53, s[16:19], s36 offen offset:1024 lds
    s_add_u32 s36, s36, s62
    s_mov_b32 m0, s49
    s_add_u32 s49, s49, s61
    buffer_load_dwordx4 v52, s[16:19], s36 offen lds
    buffer_load_dwordx4 v53, s[16:19], s36 offen offset:1024 lds
    s_add_u32 s36, s36, s63
    s_add_u32 s49, s53, 114688
    s_add_u32 s36, s52, 1490944
    s_cmp_ge_u32 s36, 1605632
    s_cselect_b32 s13, 1605632, 0
    s_sub_u32 s36, s36, s13
    s_mov_b32 m0, s49
    s_add_u32 s49, s49, s60
    buffer_load_dwordx4 v52, s[16:19], s36 offen lds
    buffer_load_dwordx4 v53, s[16:19], s36 offen offset:1024 lds
    s_add_u32 s36, s36, s62
    s_mov_b32 m0, s49
    s_add_u32 s49, s49, s61
    buffer_load_dwordx4 v52, s[16:19], s36 offen lds
    buffer_load_dwordx4 v53, s[16:19], s36 offen offset:1024 lds
    s_add_u32 s36, s36, s63
    buffer_store_dwordx4 v[64:67], v24, s[28:31], s44 offen offset:0 sc1
    buffer_store_dwordx4 v[68:71], v24, s[28:31], s45 offen offset:0 sc1
P1_eN0:
    s_cmp_ge_u32 s42, 27
    s_cbranch_scc1 P1_eV1
    v_pk_mul_f32 v[144:145], v[144:145], v[20:21]
    v_pk_mul_f32 v[146:147], v[146:147], v[20:21]
    v_pk_mul_f32 v[148:149], v[148:149], v[20:21]
    v_pk_mul_f32 v[150:151], v[150:151], v[20:21]
    v_pk_mul_f32 v[152:153], v[152:153], v[20:21]
    v_pk_mul_f32 v[154:155], v[154:155], v[20:21]
    v_pk_mul_f32 v[156:157], v[156:157], v[20:21]
    v_pk_mul_f32 v[158:159], v[158:159], v[20:21]
    v_cvt_pk_bf16_f32 v76, v144, v145
    v_cvt_pk_bf16_f32 v77, v146, v147
    v_cvt_pk_bf16_f32 v78, v148, v149
    v_cvt_pk_bf16_f32 v79, v150, v151
    v_cvt_pk_bf16_f32 v82, v152, v153
    v_cvt_pk_bf16_f32 v83, v154, v155
    v_cvt_pk_bf16_f32 v84, v156, v157
    v_cvt_pk_bf16_f32 v85, v158, v159
    v_mov_b64 v[80:81], v[16:17]
    v_cmp_gt_i32 s[4:5], 0, v36
    v_mov_b64 v[86:87], v[16:17]
    v_cmp_gt_i32 s[6:7], 0, v37
    v_permlane32_swap_b32 v76, v78
    v_permlane32_swap_b32 v77, v79
    v_permlane32_swap_b32 v82, v84
    v_permlane32_swap_b32 v83, v85
    s_cmp_eq_u64 s[4:5], -1
    s_cbranch_scc1 P1_eS10
    buffer_store_dwordx4 v[78:81], v36, s[28:31], 0 offen sc1
    s_not_b64 exec, s[4:5]
    s_nop 0
    v_mov_b64 v[78:79], v[16:17]
    s_mov_b64 exec, -1
P1_eS10:
    buffer_store_dwordx4 v[76:79], v30, s[28:31], 0 offen sc1
    s_cmp_eq_u64 s[6:7], -1
    s_cbranch_scc1 P1_eS11
    buffer_store_dwordx4 v[84:87], v37, s[28:31], 0 offen sc1
    s_not_b64 exec, s[6:7]
    s_nop 0
    v_mov_b64 v[84:85], v[16:17]
    s_mov_b64 exec, -1
P1_eS11:
    buffer_store_dwordx4 v[82:85], v31, s[28:31], 0 offen sc1
    s_waitcnt vmcnt(4)
    s_branch P1_eN1
P1_eV1:
    v_pk_mul_f32 v[144:145], v[144:145], v[192:193]
    v_pk_mul_f32 v[146:147], v[146:147], v[194:195]
    v_pk_mul_f32 v[148:149], v[148:149], v[196:197]
    v_pk_mul_f32 v[150:151], v[150:151], v[198:199]
    v_pk_mul_f32 v[152:153], v[152:153], v[200:201]
    v_pk_mul_f32 v[154:155], v[154:155], v[202:203]
    v_pk_mul_f32 v[156:157], v[156:157], v[204:205]
    v_pk_mul_f32 v[158:159], v[158:159], v[206:207]
    v_cvt_pk_bf16_f32 v76, v144, v145
    v_cvt_pk_bf16_f32 v77, v146, v147
    v_cvt_pk_bf16_f32 v78, v148, v149
    v_cvt_pk_bf16_f32 v79, v150, v151
    v_cvt_pk_bf16_f32 v80, v152, v153
    v_cvt_pk_bf16_f32 v81, v154, v155
    v_cvt_pk_bf16_f32 v82, v156, v157
    v_cvt_pk_bf16_f32 v83, v158, v159
    buffer_store_dwordx4 v[76:79], v24, s[28:31], s44 offen offset:512 sc1
    buffer_store_dwordx4 v[80:83], v24, s[28:31], s45 offen offset:512 sc1
    s_waitcnt vmcnt(4)
P1_eN1:
    s_barrier
    s_cmp_ge_u32 s42, 26
    s_cbranch_scc1 P1_eV2
    v_pk_mul_f32 v[160:161], v[160:161], v[22:23]
    v_pk_mul_f32 v[162:163], v[162:163], v[22:23]
    v_pk_mul_f32 v[164:165], v[164:165], v[22:23]
    v_pk_mul_f32 v[166:167], v[166:167], v[22:23]
    v_pk_mul_f32 v[168:169], v[168:169], v[22:23]
    v_pk_mul_f32 v[170:171], v[170:171], v[22:23]
    v_pk_mul_f32 v[172:173], v[172:173], v[22:23]
    v_pk_mul_f32 v[174:175], v[174:175], v[22:23]
    v_cvt_pk_bf16_f32 v88, v160, v161
    v_cvt_pk_bf16_f32 v89, v162, v163
    v_cvt_pk_bf16_f32 v90, v164, v165
    v_cvt_pk_bf16_f32 v91, v166, v167
    v_cvt_pk_bf16_f32 v94, v168, v169
    v_cvt_pk_bf16_f32 v95, v170, v171
    v_cvt_pk_bf16_f32 v96, v172, v173
    v_cvt_pk_bf16_f32 v97, v174, v175
    v_mov_b64 v[92:93], v[16:17]
    v_cmp_gt_i32 s[4:5], 0, v38
    v_mov_b64 v[98:99], v[16:17]
    v_cmp_gt_i32 s[6:7], 0, v39
    v_permlane32_swap_b32 v88, v90
    v_permlane32_swap_b32 v89, v91
    v_permlane32_swap_b32 v94, v96
    v_permlane32_swap_b32 v95, v97
    s_cmp_eq_u64 s[4:5], -1
    s_cbranch_scc1 P1_eS20
    buffer_store_dwordx4 v[90:93], v38, s[28:31], 0 offen sc1
    s_not_b64 exec, s[4:5]
    s_nop 0
    v_mov_b64 v[90:91], v[16:17]
    s_mov_b64 exec, -1
P1_eS20:
    buffer_store_dwordx4 v[88:91], v32, s[28:31], 0 offen sc1
    s_cmp_eq_u64 s[6:7], -1
    s_cbranch_scc1 P1_eS21
    buffer_store_dwordx4 v[96:99], v39, s[28:31], 0 offen sc1
    s_not_b64 exec, s[6:7]
    s_nop 0
    v_mov_b64 v[96:97], v[16:17]
    s_mov_b64 exec, -1
P1_eS21:
    buffer_store_dwordx4 v[94:97], v33, s[28:31], 0 offen sc1
    s_branch P1_eN2
P1_eV2:
    v_pk_mul_f32 v[160:161], v[160:161], v[192:193]
    v_pk_mul_f32 v[162:163], v[162:163], v[194:195]
    v_pk_mul_f32 v[164:165], v[164:165], v[196:197]
    v_pk_mul_f32 v[166:167], v[166:167], v[198:199]
    v_pk_mul_f32 v[168:169], v[168:169], v[200:201]
    v_pk_mul_f32 v[170:171], v[170:171], v[202:203]
    v_pk_mul_f32 v[172:173], v[172:173], v[204:205]
    v_pk_mul_f32 v[174:175], v[174:175], v[206:207]
    v_cvt_pk_bf16_f32 v88, v160, v161
    v_cvt_pk_bf16_f32 v89, v162, v163
    v_cvt_pk_bf16_f32 v90, v164, v165
    v_cvt_pk_bf16_f32 v91, v166, v167
    v_cvt_pk_bf16_f32 v92, v168, v169
    v_cvt_pk_bf16_f32 v93, v170, v171
    v_cvt_pk_bf16_f32 v94, v172, v173
    v_cvt_pk_bf16_f32 v95, v174, v175
    buffer_store_dwordx4 v[88:91], v24, s[28:31], s44 offen offset:1024 sc1
    buffer_store_dwordx4 v[92:95], v24, s[28:31], s45 offen offset:1024 sc1
P1_eN2:
    v_mov_b32 v15, 0
    s_mul_i32 s44, s34, 96
    s_mul_i32 s42, s44, 2341
    s_lshr_b32 s42, s42, 16
    v_lshrrev_b32 v8, 1, v1
    v_add_u32 v8, s42, v8
    v_and_b32 v10, 1, v1
    v_mul_u32_u24 v9, 27, v10
    v_mad_u32_u24 v9, v8, 28, v9
    v_subrev_u32 v9, s44, v9
    v_cmp_gt_u32 vcc, 96, v9
    v_lshlrev_b32 v10, 4, v10
    v_lshrrev_b32 v9, 4, v8
    v_lshl_add_u32 v10, v9, 2, v10
    v_and_b32 v9, 15, v8
    v_lshl_add_u32 v10, v9, 11, v10
    v_cndmask_b32 v10, -1, v10, vcc
    s_lshl_b32 s45, s33, 7
    s_add_u32 s45, s45, 17825792
    v_mov_b32 v4, 155648
    v_mov_b32 v5, 1
    s_mov_b64 exec, 1
    s_waitcnt vmcnt(0)
    ds_add_rtn_u32 v6, v4, v5
    s_waitcnt lgkmcnt(0)
    v_readfirstlane_b32 s42, v6
    s_mov_b64 exec, 0x3ff
    s_cmp_lg_u32 s42, 3
    s_cbranch_scc1 F_sq_ns
    buffer_store_dword v5, v10, s[28:31], s45 offen sc1
F_sq_ns:
    s_mov_b64 exec, -1
F_att:
    s_and_b32 s36, s2, 7
    s_lshl_b32 s36, s36, 1
    s_bfe_u32 s42, s2, 0x10003
    s_add_u32 s36, s36, s42
    s_lshr_b32 s37, s2, 4
    s_mov_b32 s50, 0x0fffffff
    s_mov_b32 s51, 0x0fffffff
    s_mov_b32 s52, 0
    s_mov_b32 s53, -1
    v_mov_b64 v[56:57], 0
    s_mov_b32 exec_lo, 0x10000000
    s_mov_b32 exec_hi, 0x10000000
    v_mov_b32 v56, 0x3f803f80
    v_mov_b32 v57, 0x3f803f80
    s_mov_b64 exec, -1
    v_mov_b64 v[58:59], v[56:57]
    v_mov_b64 v[60:61], v[56:57]
    v_mov_b64 v[62:63], v[56:57]
    v_mov_b64 v[72:73], v[56:57]
    v_mov_b64 v[74:75], v[56:57]
    v_mov_b64 v[76:77], v[56:57]
    v_mov_b64 v[78:79], v[56:57]
    v_mov_b64 v[88:89], v[56:57]
    v_mov_b64 v[90:91], v[56:57]
    v_mov_b64 v[92:93], v[56:57]
    v_mov_b64 v[94:95], v[56:57]
    v_mov_b64 v[104:105], v[56:57]
    v_mov_b64 v[106:107], v[56:57]
    v_mov_b64 v[108:109], v[56:57]
    v_mov_b64 v[110:111], v[56:57]
    v_mul_u32_u24 v14, 6656, v3
    v_add_u32 v14, v14, v2
    s_mul_i32 s42, s36, 448
    v_add_u32 v14, s42, v14
    v_add_u32 v13, 14336, v14
    s_lshl_b32 s43, s36, 18
    s_add_u32 s4, s28, s43
    s_addc_u32 s5, s29, 0
    s_mov_b32 s6, 262144
    s_mov_b32 s7, 0x20000
    s_lshl_b32 s43, s32, 16
    s_add_u32 s8, s4, s43
    s_addc_u32 s9, s5, 0
    s_mov_b32 s10, 65536
    s_mov_b32 s11, 0x20000
    s_add_u32 s16, s28, 4194304
    s_addc_u32 s17, s29, 0
    s_mov_b32 s18, 1835008
    s_mov_b32 s19, 0x20000
    s_mul_i32 s43, s32, 458752
    s_add_u32 s20, s16, s43
    s_addc_u32 s21, s17, 0
    s_mov_b32 s22, 458752
    s_mov_b32 s23, 0x20000
    s_mov_b32 s39, 0
    s_mov_b32 s38, 0
    v_mov_b64 v[152:153], 0
    v_mov_b64 v[154:155], 0
    v_mov_b64 v[156:157], 0
    v_mov_b64 v[158:159], 0
    s_and_b32 s47, s2, 7
    s_lshl_b32 s47, s47, 2
    s_bfe_u32 s42, s2, 0x20003
    s_add_u32 s47, s47, s42
    s_lshr_b32 s48, s2, 5
    s_lshr_b32 s15, s32, 1
    s_lshl_b32 s45, s36, 11
    s_add_u32 s45, s45, 17825792
    s_mov_b32 s43, 0x8000
    v_mov_b32 v9, 155660
    s_cmp_lg_u32 s32, 0
    s_cbranch_scc1 F_pq_w
    s_mov_b32 exec_hi, 0
    v_lshrrev_b32 v8, 1, v1
    v_mul_u32_u24 v8, 96, v8
    v_add_u32 v8, v8, v2
F_pq_l:
    buffer_load_dwordx3 v[4:6], v8, s[28:31], s45 offen sc1
    s_waitcnt vmcnt(0)
    v_and_b32 v4, v4, v5
    v_and_b32 v4, v4, v6
    v_cmp_ne_u32 vcc, 1, v4
    s_cbranch_vccz F_pq_p
    s_sub_u32 s43, s43, 1
    s_cbranch_scc1 F_pq_p
    s_sleep 3
    s_branch F_pq_l
F_pq_p:
    v_mov_b32 v4, 1
    ds_write_b32 v9, v4
    s_mov_b64 exec, -1
    s_branch F_pq_ok
F_pq_w:
    s_lshl_b32 s43, s43, 4
F_pq_w2:
    ds_read_b32 v4, v9
    s_waitcnt lgkmcnt(0)
    v_readfirstlane_b32 s42, v4
    s_cmp_eq_u32 s42, 1
    s_cbranch_scc1 F_pq_ok
    s_sub_u32 s43, s43, 1
    s_cbranch_scc1 F_pq_ok
    s_sleep 2
    s_branch F_pq_w2
F_pq_ok:
    s_setprio 1
    buffer_load_dwordx4 v[144:147], v2, s[4:7], 0 offen sc1
    buffer_load_dwordx4 v[148:151], v2, s[4:7], 0 offen offset:1024 sc1
    s_lshl_b32 s43, s37, 14
    s_add_u32 s42, s32, 0
    s_and_b32 s42, s42, 3
    s_lshl_b32 s42, s42, 12
    s_add_u32 s42, s42, s43
    buffer_load_dwordx4 v[16:19], v2, s[4:7], s42 offen offset:2048 sc1
    buffer_load_dwordx4 v[20:23], v2, s[4:7], s42 offen offset:3072 sc1
    s_add_u32 s42, s32, 1
    s_and_b32 s42, s42, 3
    s_lshl_b32 s42, s42, 12
    s_add_u32 s42, s42, s43
    buffer_load_dwordx4 v[24:27], v2, s[4:7], s42 offen offset:2048 sc1
    buffer_load_dwordx4 v[28:31], v2, s[4:7], s42 offen offset:3072 sc1
    s_add_u32 s42, s32, 2
    s_and_b32 s42, s42, 3
    s_lshl_b32 s42, s42, 12
    s_add_u32 s42, s42, s43
    buffer_load_dwordx4 v[32:35], v2, s[4:7], s42 offen offset:2048 sc1
    buffer_load_dwordx4 v[36:39], v2, s[4:7], s42 offen offset:3072 sc1
    s_add_u32 s42, s32, 3
    s_and_b32 s42, s42, 3
    s_lshl_b32 s42, s42, 12
    s_add_u32 s42, s42, s43
    buffer_load_dwordx4 v[40:43], v2, s[4:7], s42 offen offset:2048 sc1
    buffer_load_dwordx4 v[44:47], v2, s[4:7], s42 offen offset:3072 sc1
    buffer_load_dwordx4 v[48:51], v2, s[8:11], s38 offen sc1
    buffer_load_dwordx4 v[52:55], v2, s[8:11], s38 offen offset:1024 sc1
    s_mov_b64 exec, s[50:51]
    buffer_load_dwordx4 v[56:59], v14, s[20:23], s39 offen sc1
    s_add_u32 s39, s39, 14336
    buffer_load_dwordx4 v[60:63], v14, s[20:23], s39 offen sc1
    s_mov_b64 exec, -1
    s_add_u32 s39, s39, 14336
    s_add_u32 s38, s38, 4096
    buffer_load_dwordx4 v[64:67], v2, s[8:11], s38 offen sc1
    buffer_load_dwordx4 v[68:71], v2, s[8:11], s38 offen offset:1024 sc1
    s_mov_b64 exec, s[50:51]
    buffer_load_dwordx4 v[72:75], v14, s[20:23], s39 offen sc1
    s_add_u32 s39, s39, 14336
    buffer_load_dwordx4 v[76:79], v14, s[20:23], s39 offen sc1
    s_mov_b64 exec, -1
    s_add_u32 s39, s39, 14336
    s_add_u32 s38, s38, 4096
    buffer_load_dwordx4 v[80:83], v2, s[8:11], s38 offen sc1
    buffer_load_dwordx4 v[84:87], v2, s[8:11], s38 offen offset:1024 sc1
    s_mov_b64 exec, s[50:51]
    buffer_load_dwordx4 v[88:91], v14, s[20:23], s39 offen sc1
    s_add_u32 s39, s39, 14336
    buffer_load_dwordx4 v[92:95], v14, s[20:23], s39 offen sc1
    s_mov_b64 exec, -1
    s_add_u32 s39, s39, 14336
    s_add_u32 s38, s38, 4096
    v_mov_b32 v10, 155688
    v_mov_b32 v11, 1
    s_mov_b64 exec, 1
    ds_add_u32 v10, v11
    s_mov_b64 exec, -1
    s_waitcnt vmcnt(12)
    s_mov_b64 exec, s[52:53]
    v_mov_b64 v[22:23], 0
    v_mov_b64 v[30:31], 0
    v_mov_b64 v[38:39], 0
    v_mov_b64 v[46:47], 0
    s_mov_b64 exec, -1
    s_nop 1
    v_mfma_f32_32x32x16_bf16 v[160:175], v[144:147], v[16:19], 0
    v_mfma_f32_32x32x16_bf16 v[160:175], v[148:151], v[20:23], v[160:175]
    v_mfma_f32_32x32x16_bf16 v[176:191], v[144:147], v[24:27], 0
    v_mfma_f32_32x32x16_bf16 v[176:191], v[148:151], v[28:31], v[176:191]
    v_mfma_f32_32x32x16_bf16 v[192:207], v[144:147], v[32:35], 0
    v_mfma_f32_32x32x16_bf16 v[192:207], v[148:151], v[36:39], v[192:207]
    v_mfma_f32_32x32x16_bf16 v[208:223], v[144:147], v[40:43], 0
    v_mfma_f32_32x32x16_bf16 v[208:223], v[148:151], v[44:47], v[208:223]
    s_nop 5
    s_mov_b64 exec, s[52:53]
    v_max3_f32 v4, v160, v161, v162
    v_max_f32 v4, v4, v163
    v_lshrrev_b32 v4, 16, v4
    v_xor_b32 v22, 0x8000, v4
    v_max3_f32 v5, v176, v177, v178
    v_max_f32 v5, v5, v179
    v_lshrrev_b32 v5, 16, v5
    v_xor_b32 v30, 0x8000, v5
    v_max3_f32 v6, v192, v193, v194
    v_max_f32 v6, v6, v195
    v_lshrrev_b32 v6, 16, v6
    v_xor_b32 v38, 0x8000, v6
    v_max3_f32 v7, v208, v209, v210
    v_max_f32 v7, v7, v211
    v_lshrrev_b32 v7, 16, v7
    v_xor_b32 v46, 0x8000, v7
    s_mov_b64 exec, -1
    s_waitcnt vmcnt(8)
    v_mfma_f32_32x32x16_bf16 v[112:127], v[48:51], v[16:19], 0
    v_mfma_f32_32x32x16_bf16 v[112:127], v[52:55], v[20:23], v[112:127]
    v_mfma_f32_32x32x16_bf16 v[160:175], v[152:155], v[152:155], 0
    v_mfma_f32_32x32x16_bf16 v[176:191], v[152:155], v[152:155], 0
    v_mfma_f32_32x32x16_bf16 v[192:207], v[152:155], v[152:155], 0
    v_mfma_f32_32x32x16_bf16 v[208:223], v[152:155], v[152:155], 0
    s_add_u32 s42, s32, 1
    s_and_b32 s42, s42, 3
    s_mul_i32 s42, s42, 12288
    v_add_u32 v5, s42, v2
    s_add_u32 s42, s32, 2
    s_and_b32 s42, s42, 3
    s_mul_i32 s42, s42, 12288
    v_add_u32 v6, s42, v2
    s_add_u32 s42, s32, 3
    s_and_b32 s42, s42, 3
    s_mul_i32 s42, s42, 12288
    v_add_u32 v7, s42, v2
    s_mov_b32 s41, 4
    s_setprio 1
F_aloop:
    v_mfma_f32_32x32x16_bf16 v[128:143], v[48:51], v[24:27], 0
    v_exp_f32 v112, v112
    v_exp_f32 v113, v113
    v_exp_f32 v114, v114
    v_mfma_f32_32x32x16_bf16 v[128:143], v[52:55], v[28:31], v[128:143]
    v_exp_f32 v115, v115
    v_exp_f32 v116, v116
    v_exp_f32 v117, v117
    v_mfma_f32_32x32x16_bf16 v[208:223], v[104:107], v[152:155], v[208:223]
    v_exp_f32 v118, v118
    v_exp_f32 v119, v119
    v_exp_f32 v120, v120
    v_mfma_f32_32x32x16_bf16 v[208:223], v[108:111], v[156:159], v[208:223]
    v_exp_f32 v121, v121
    buffer_load_dwordx4 v[96:99], v2, s[8:11], s38 offen sc1
    v_exp_f32 v122, v122
    v_exp_f32 v123, v123
    buffer_load_dwordx4 v[100:103], v2, s[8:11], s38 offen offset:1024 sc1
    v_exp_f32 v124, v124
    v_exp_f32 v125, v125
    s_add_u32 s38, s38, 4096
    v_exp_f32 v126, v126
    v_exp_f32 v127, v127
    v_cvt_pk_bf16_f32 v144, v112, v113
    v_cvt_pk_bf16_f32 v145, v114, v115
    v_cvt_pk_bf16_f32 v146, v116, v117
    v_cvt_pk_bf16_f32 v147, v118, v119
    v_cvt_pk_bf16_f32 v148, v120, v121
    v_cvt_pk_bf16_f32 v149, v122, v123
    v_cvt_pk_bf16_f32 v150, v124, v125
    v_cvt_pk_bf16_f32 v151, v126, v127
    v_mfma_f32_32x32x16_bf16 v[112:127], v[48:51], v[32:35], 0
    v_exp_f32 v128, v128
    v_exp_f32 v129, v129
    v_exp_f32 v130, v130
    v_mfma_f32_32x32x16_bf16 v[112:127], v[52:55], v[36:39], v[112:127]
    v_exp_f32 v131, v131
    v_exp_f32 v132, v132
    v_exp_f32 v133, v133
    v_mfma_f32_32x32x16_bf16 v[160:175], v[56:59], v[144:147], v[160:175]
    v_exp_f32 v134, v134
    v_exp_f32 v135, v135
    v_exp_f32 v136, v136
    v_mfma_f32_32x32x16_bf16 v[160:175], v[60:63], v[148:151], v[160:175]
    v_exp_f32 v137, v137
    s_mov_b64 exec, s[50:51]
    buffer_load_dwordx4 v[104:107], v14, s[20:23], s39 offen sc1
    buffer_load_dwordx4 v[108:111], v13, s[20:23], s39 offen sc1
    s_mov_b64 exec, -1
    v_exp_f32 v138, v138
    v_exp_f32 v139, v139
    s_add_u32 s39, s39, 28672
    v_exp_f32 v140, v140
    v_exp_f32 v141, v141
    v_exp_f32 v142, v142
    v_exp_f32 v143, v143
    v_cvt_pk_bf16_f32 v152, v128, v129
    v_cvt_pk_bf16_f32 v153, v130, v131
    v_cvt_pk_bf16_f32 v154, v132, v133
    v_cvt_pk_bf16_f32 v155, v134, v135
    v_cvt_pk_bf16_f32 v156, v136, v137
    v_cvt_pk_bf16_f32 v157, v138, v139
    v_cvt_pk_bf16_f32 v158, v140, v141
    v_cvt_pk_bf16_f32 v159, v142, v143
    v_mfma_f32_32x32x16_bf16 v[128:143], v[48:51], v[40:43], 0
    v_exp_f32 v112, v112
    v_exp_f32 v113, v113
    v_exp_f32 v114, v114
    v_mfma_f32_32x32x16_bf16 v[128:143], v[52:55], v[44:47], v[128:143]
    v_exp_f32 v115, v115
    v_exp_f32 v116, v116
    v_exp_f32 v117, v117
    v_mfma_f32_32x32x16_bf16 v[176:191], v[56:59], v[152:155], v[176:191]
    v_exp_f32 v118, v118
    v_exp_f32 v119, v119
    v_exp_f32 v120, v120
    v_mfma_f32_32x32x16_bf16 v[176:191], v[60:63], v[156:159], v[176:191]
    v_exp_f32 v121, v121
    v_exp_f32 v122, v122
    v_exp_f32 v123, v123
    v_exp_f32 v124, v124
    v_exp_f32 v125, v125
    v_exp_f32 v126, v126
    v_exp_f32 v127, v127
    v_cvt_pk_bf16_f32 v144, v112, v113
    v_cvt_pk_bf16_f32 v145, v114, v115
    v_cvt_pk_bf16_f32 v146, v116, v117
    v_cvt_pk_bf16_f32 v147, v118, v119
    v_cvt_pk_bf16_f32 v148, v120, v121
    v_cvt_pk_bf16_f32 v149, v122, v123
    v_cvt_pk_bf16_f32 v150, v124, v125
    v_cvt_pk_bf16_f32 v151, v126, v127
    s_cmp_lg_u32 s41, 1
    s_cbranch_scc1 F_bw0
    v_mov_b32 v10, 155652
    s_mov_b32 s43, 0x80000
    s_branch F_bw1
F_bw1_s:
    s_sleep 2
F_bw1:
    ds_read_b32 v11, v10
    s_waitcnt lgkmcnt(0)
    v_readfirstlane_b32 s42, v11
    s_sub_u32 s43, s43, 1
    s_cselect_b32 s42, 4, s42
    s_cmp_lt_u32 s42, 4
    s_cbranch_scc1 F_bw1_s
F_bw0:
    s_waitcnt vmcnt(8)
    v_mfma_f32_32x32x16_bf16 v[112:127], v[64:67], v[16:19], 0
    v_exp_f32 v128, v128
    v_exp_f32 v129, v129
    v_exp_f32 v130, v130
    v_mfma_f32_32x32x16_bf16 v[112:127], v[68:71], v[20:23], v[112:127]
    v_exp_f32 v131, v131
    v_exp_f32 v132, v132
    v_exp_f32 v133, v133
    v_mfma_f32_32x32x16_bf16 v[192:207], v[56:59], v[144:147], v[192:207]
    v_exp_f32 v134, v134
    v_exp_f32 v135, v135
    v_exp_f32 v136, v136
    v_mfma_f32_32x32x16_bf16 v[192:207], v[60:63], v[148:151], v[192:207]
    v_exp_f32 v137, v137
    v_exp_f32 v138, v138
    v_exp_f32 v139, v139
    v_exp_f32 v140, v140
    v_exp_f32 v141, v141
    v_exp_f32 v142, v142
    v_exp_f32 v143, v143
    v_cvt_pk_bf16_f32 v152, v128, v129
    v_cvt_pk_bf16_f32 v153, v130, v131
    v_cvt_pk_bf16_f32 v154, v132, v133
    v_cvt_pk_bf16_f32 v155, v134, v135
    v_cvt_pk_bf16_f32 v156, v136, v137
    v_cvt_pk_bf16_f32 v157, v138, v139
    v_cvt_pk_bf16_f32 v158, v140, v141
    v_cvt_pk_bf16_f32 v159, v142, v143
    v_mfma_f32_32x32x16_bf16 v[128:143], v[64:67], v[24:27], 0
    v_exp_f32 v112, v112
    v_exp_f32 v113, v113
    v_exp_f32 v114, v114
    v_mfma_f32_32x32x16_bf16 v[128:143], v[68:71], v[28:31], v[128:143]
    v_exp_f32 v115, v115
    v_exp_f32 v116, v116
    v_exp_f32 v117, v117
    v_mfma_f32_32x32x16_bf16 v[208:223], v[56:59], v[152:155], v[208:223]
    v_exp_f32 v118, v118
    v_exp_f32 v119, v119
    v_exp_f32 v120, v120
    v_mfma_f32_32x32x16_bf16 v[208:223], v[60:63], v[156:159], v[208:223]
    v_exp_f32 v121, v121
    buffer_load_dwordx4 v[48:51], v2, s[8:11], s38 offen sc1
    v_exp_f32 v122, v122
    v_exp_f32 v123, v123
    buffer_load_dwordx4 v[52:55], v2, s[8:11], s38 offen offset:1024 sc1
    v_exp_f32 v124, v124
    v_exp_f32 v125, v125
    s_add_u32 s38, s38, 4096
    v_exp_f32 v126, v126
    v_exp_f32 v127, v127
    v_cvt_pk_bf16_f32 v144, v112, v113
    v_cvt_pk_bf16_f32 v145, v114, v115
    v_cvt_pk_bf16_f32 v146, v116, v117
    v_cvt_pk_bf16_f32 v147, v118, v119
    v_cvt_pk_bf16_f32 v148, v120, v121
    v_cvt_pk_bf16_f32 v149, v122, v123
    v_cvt_pk_bf16_f32 v150, v124, v125
    v_cvt_pk_bf16_f32 v151, v126, v127
    v_mfma_f32_32x32x16_bf16 v[112:127], v[64:67], v[32:35], 0
    v_exp_f32 v128, v128
    v_exp_f32 v129, v129
    v_exp_f32 v130, v130
    v_mfma_f32_32x32x16_bf16 v[112:127], v[68:71], v[36:39], v[112:127]
    v_exp_f32 v131, v131
    v_exp_f32 v132, v132
    v_exp_f32 v133, v133
    v_mfma_f32_32x32x16_bf16 v[160:175], v[72:75], v[144:147], v[160:175]
    v_exp_f32 v134, v134
    v_exp_f32 v135, v135
    v_exp_f32 v136, v136
    v_mfma_f32_32x32x16_bf16 v[160:175], v[76:79], v[148:151], v[160:175]
    v_exp_f32 v137, v137
    s_mov_b64 exec, s[50:51]
    buffer_load_dwordx4 v[56:59], v14, s[20:23], s39 offen sc1
    buffer_load_dwordx4 v[60:63], v13, s[20:23], s39 offen sc1
    s_mov_b64 exec, -1
    v_exp_f32 v138, v138
    v_exp_f32 v139, v139
    s_add_u32 s39, s39, 28672
    v_exp_f32 v140, v140
    v_exp_f32 v141, v141
    v_exp_f32 v142, v142
    v_exp_f32 v143, v143
    v_cvt_pk_bf16_f32 v152, v128, v129
    v_cvt_pk_bf16_f32 v153, v130, v131
    v_cvt_pk_bf16_f32 v154, v132, v133
    v_cvt_pk_bf16_f32 v155, v134, v135
    v_cvt_pk_bf16_f32 v156, v136, v137
    v_cvt_pk_bf16_f32 v157, v138, v139
    v_cvt_pk_bf16_f32 v158, v140, v141
    v_cvt_pk_bf16_f32 v159, v142, v143
    v_mfma_f32_32x32x16_bf16 v[128:143], v[64:67], v[40:43], 0
    v_exp_f32 v112, v112
    v_exp_f32 v113, v113
    v_exp_f32 v114, v114
    v_mfma_f32_32x32x16_bf16 v[128:143], v[68:71], v[44:47], v[128:143]
    v_exp_f32 v115, v115
    v_exp_f32 v116, v116
    v_exp_f32 v117, v117
    v_mfma_f32_32x32x16_bf16 v[176:191], v[72:75], v[152:155], v[176:191]
    v_exp_f32 v118, v118
    v_exp_f32 v119, v119
    v_exp_f32 v120, v120
    v_mfma_f32_32x32x16_bf16 v[176:191], v[76:79], v[156:159], v[176:191]
    v_exp_f32 v121, v121
    v_exp_f32 v122, v122
    v_exp_f32 v123, v123
    v_exp_f32 v124, v124
    v_exp_f32 v125, v125
    v_exp_f32 v126, v126
    v_exp_f32 v127, v127
    v_cvt_pk_bf16_f32 v144, v112, v113
    v_cvt_pk_bf16_f32 v145, v114, v115
    v_cvt_pk_bf16_f32 v146, v116, v117
    v_cvt_pk_bf16_f32 v147, v118, v119
    v_cvt_pk_bf16_f32 v148, v120, v121
    v_cvt_pk_bf16_f32 v149, v122, v123
    v_cvt_pk_bf16_f32 v150, v124, v125
    v_cvt_pk_bf16_f32 v151, v126, v127
    s_waitcnt vmcnt(8)
    v_mfma_f32_32x32x16_bf16 v[112:127], v[80:83], v[16:19], 0
    v_exp_f32 v128, v128
    v_exp_f32 v129, v129
    v_exp_f32 v130, v130
    v_mfma_f32_32x32x16_bf16 v[112:127], v[84:87], v[20:23], v[112:127]
    v_exp_f32 v131, v131
    v_exp_f32 v132, v132
    v_exp_f32 v133, v133
    v_mfma_f32_32x32x16_bf16 v[192:207], v[72:75], v[144:147], v[192:207]
    v_exp_f32 v134, v134
    v_exp_f32 v135, v135
    v_exp_f32 v136, v136
    v_mfma_f32_32x32x16_bf16 v[192:207], v[76:79], v[148:151], v[192:207]
    v_exp_f32 v137, v137
    v_exp_f32 v138, v138
    v_exp_f32 v139, v139
    v_exp_f32 v140, v140
    v_exp_f32 v141, v141
    v_exp_f32 v142, v142
    v_exp_f32 v143, v143
    v_cvt_pk_bf16_f32 v152, v128, v129
    v_cvt_pk_bf16_f32 v153, v130, v131
    v_cvt_pk_bf16_f32 v154, v132, v133
    v_cvt_pk_bf16_f32 v155, v134, v135
    v_cvt_pk_bf16_f32 v156, v136, v137
    v_cvt_pk_bf16_f32 v157, v138, v139
    v_cvt_pk_bf16_f32 v158, v140, v141
    v_cvt_pk_bf16_f32 v159, v142, v143
    v_mfma_f32_32x32x16_bf16 v[128:143], v[80:83], v[24:27], 0
    v_exp_f32 v112, v112
    v_exp_f32 v113, v113
    v_exp_f32 v114, v114
    v_mfma_f32_32x32x16_bf16 v[128:143], v[84:87], v[28:31], v[128:143]
    v_exp_f32 v115, v115
    v_exp_f32 v116, v116
    v_exp_f32 v117, v117
    v_mfma_f32_32x32x16_bf16 v[208:223], v[72:75], v[152:155], v[208:223]
    v_exp_f32 v118, v118
    v_exp_f32 v119, v119
    v_exp_f32 v120, v120
    v_mfma_f32_32x32x16_bf16 v[208:223], v[76:79], v[156:159], v[208:223]
    v_exp_f32 v121, v121
    buffer_load_dwordx4 v[64:67], v2, s[8:11], s38 offen sc1
    v_exp_f32 v122, v122
    v_exp_f32 v123, v123
    buffer_load_dwordx4 v[68:71], v2, s[8:11], s38 offen offset:1024 sc1
    v_exp_f32 v124, v124
    v_exp_f32 v125, v125
    s_add_u32 s38, s38, 4096
    v_exp_f32 v126, v126
    v_exp_f32 v127, v127
    v_cvt_pk_bf16_f32 v144, v112, v113
    v_cvt_pk_bf16_f32 v145, v114, v115
    v_cvt_pk_bf16_f32 v146, v116, v117
    v_cvt_pk_bf16_f32 v147, v118, v119
    v_cvt_pk_bf16_f32 v148, v120, v121
    v_cvt_pk_bf16_f32 v149, v122, v123
    v_cvt_pk_bf16_f32 v150, v124, v125
    v_cvt_pk_bf16_f32 v151, v126, v127
    v_mfma_f32_32x32x16_bf16 v[112:127], v[80:83], v[32:35], 0
    v_exp_f32 v128, v128
    v_exp_f32 v129, v129
    v_exp_f32 v130, v130
    v_mfma_f32_32x32x16_bf16 v[112:127], v[84:87], v[36:39], v[112:127]
    v_exp_f32 v131, v131
    v_exp_f32 v132, v132
    v_exp_f32 v133, v133
    v_mfma_f32_32x32x16_bf16 v[160:175], v[88:91], v[144:147], v[160:175]
    v_exp_f32 v134, v134
    v_exp_f32 v135, v135
    v_exp_f32 v136, v136
    v_mfma_f32_32x32x16_bf16 v[160:175], v[92:95], v[148:151], v[160:175]
    v_exp_f32 v137, v137
    s_mov_b64 exec, s[50:51]
    buffer_load_dwordx4 v[72:75], v14, s[20:23], s39 offen sc1
    buffer_load_dwordx4 v[76:79], v13, s[20:23], s39 offen sc1
    s_mov_b64 exec, -1
    v_exp_f32 v138, v138
    v_exp_f32 v139, v139
    s_add_u32 s39, s39, 28672
    v_exp_f32 v140, v140
    v_exp_f32 v141, v141
    v_exp_f32 v142, v142
    v_exp_f32 v143, v143
    v_cvt_pk_bf16_f32 v152, v128, v129
    v_cvt_pk_bf16_f32 v153, v130, v131
    v_cvt_pk_bf16_f32 v154, v132, v133
    v_cvt_pk_bf16_f32 v155, v134, v135
    v_cvt_pk_bf16_f32 v156, v136, v137
    v_cvt_pk_bf16_f32 v157, v138, v139
    v_cvt_pk_bf16_f32 v158, v140, v141
    v_cvt_pk_bf16_f32 v159, v142, v143
    v_mfma_f32_32x32x16_bf16 v[128:143], v[80:83], v[40:43], 0
    v_exp_f32 v112, v112
    v_exp_f32 v113, v113
    v_exp_f32 v114, v114
    v_mfma_f32_32x32x16_bf16 v[128:143], v[84:87], v[44:47], v[128:143]
    v_exp_f32 v115, v115
    v_exp_f32 v116, v116
    v_exp_f32 v117, v117
    v_mfma_f32_32x32x16_bf16 v[176:191], v[88:91], v[152:155], v[176:191]
    v_exp_f32 v118, v118
    v_exp_f32 v119, v119
    v_exp_f32 v120, v120
    v_mfma_f32_32x32x16_bf16 v[176:191], v[92:95], v[156:159], v[176:191]
    v_exp_f32 v121, v121
    v_exp_f32 v122, v122
    v_exp_f32 v123, v123
    v_exp_f32 v124, v124
    v_exp_f32 v125, v125
    v_exp_f32 v126, v126
    v_exp_f32 v127, v127
    v_cvt_pk_bf16_f32 v144, v112, v113
    v_cvt_pk_bf16_f32 v145, v114, v115
    v_cvt_pk_bf16_f32 v146, v116, v117
    v_cvt_pk_bf16_f32 v147, v118, v119
    v_cvt_pk_bf16_f32 v148, v120, v121
    v_cvt_pk_bf16_f32 v149, v122, v123
    v_cvt_pk_bf16_f32 v150, v124, v125
    v_cvt_pk_bf16_f32 v151, v126, v127
    s_waitcnt vmcnt(8)
    v_mfma_f32_32x32x16_bf16 v[112:127], v[96:99], v[16:19], 0
    v_exp_f32 v128, v128
    v_exp_f32 v129, v129
    v_exp_f32 v130, v130
    v_mfma_f32_32x32x16_bf16 v[112:127], v[100:103], v[20:23], v[112:127]
    v_exp_f32 v131, v131
    v_exp_f32 v132, v132
    v_exp_f32 v133, v133
    v_mfma_f32_32x32x16_bf16 v[192:207], v[88:91], v[144:147], v[192:207]
    v_exp_f32 v134, v134
    v_exp_f32 v135, v135
    v_exp_f32 v136, v136
    v_mfma_f32_32x32x16_bf16 v[192:207], v[92:95], v[148:151], v[192:207]
    v_exp_f32 v137, v137
    v_exp_f32 v138, v138
    v_exp_f32 v139, v139
    v_exp_f32 v140, v140
    v_exp_f32 v141, v141
    v_exp_f32 v142, v142
    v_exp_f32 v143, v143
    v_cvt_pk_bf16_f32 v152, v128, v129
    v_cvt_pk_bf16_f32 v153, v130, v131
    v_cvt_pk_bf16_f32 v154, v132, v133
    v_cvt_pk_bf16_f32 v155, v134, v135
    v_cvt_pk_bf16_f32 v156, v136, v137
    v_cvt_pk_bf16_f32 v157, v138, v139
    v_cvt_pk_bf16_f32 v158, v140, v141
    v_cvt_pk_bf16_f32 v159, v142, v143
    v_mfma_f32_32x32x16_bf16 v[128:143], v[96:99], v[24:27], 0
    v_exp_f32 v112, v112
    v_exp_f32 v113, v113
    v_exp_f32 v114, v114
    v_mfma_f32_32x32x16_bf16 v[128:143], v[100:103], v[28:31], v[128:143]
    v_exp_f32 v115, v115
    v_exp_f32 v116, v116
    v_exp_f32 v117, v117
    v_mfma_f32_32x32x16_bf16 v[208:223], v[88:91], v[152:155], v[208:223]
    v_exp_f32 v118, v118
    v_exp_f32 v119, v119
    v_exp_f32 v120, v120
    v_mfma_f32_32x32x16_bf16 v[208:223], v[92:95], v[156:159], v[208:223]
    v_exp_f32 v121, v121
    buffer_load_dwordx4 v[80:83], v2, s[8:11], s38 offen sc1
    v_exp_f32 v122, v122
    v_exp_f32 v123, v123
    buffer_load_dwordx4 v[84:87], v2, s[8:11], s38 offen offset:1024 sc1
    v_exp_f32 v124, v124
    v_exp_f32 v125, v125
    s_add_u32 s38, s38, 4096
    v_exp_f32 v126, v126
    v_exp_f32 v127, v127
    v_cvt_pk_bf16_f32 v144, v112, v113
    v_cvt_pk_bf16_f32 v145, v114, v115
    v_cvt_pk_bf16_f32 v146, v116, v117
    v_cvt_pk_bf16_f32 v147, v118, v119
    v_cvt_pk_bf16_f32 v148, v120, v121
    v_cvt_pk_bf16_f32 v149, v122, v123
    v_cvt_pk_bf16_f32 v150, v124, v125
    v_cvt_pk_bf16_f32 v151, v126, v127
    v_mfma_f32_32x32x16_bf16 v[112:127], v[96:99], v[32:35], 0
    v_exp_f32 v128, v128
    v_exp_f32 v129, v129
    v_exp_f32 v130, v130
    v_mfma_f32_32x32x16_bf16 v[112:127], v[100:103], v[36:39], v[112:127]
    v_exp_f32 v131, v131
    v_exp_f32 v132, v132
    v_exp_f32 v133, v133
    v_mfma_f32_32x32x16_bf16 v[160:175], v[104:107], v[144:147], v[160:175]
    v_exp_f32 v134, v134
    v_exp_f32 v135, v135
    v_exp_f32 v136, v136
    v_mfma_f32_32x32x16_bf16 v[160:175], v[108:111], v[148:151], v[160:175]
    v_exp_f32 v137, v137
    s_mov_b64 exec, s[50:51]
    buffer_load_dwordx4 v[88:91], v14, s[20:23], s39 offen sc1
    buffer_load_dwordx4 v[92:95], v13, s[20:23], s39 offen sc1
    s_mov_b64 exec, -1
    v_exp_f32 v138, v138
    v_exp_f32 v139, v139
    s_add_u32 s39, s39, 28672
    v_exp_f32 v140, v140
    v_exp_f32 v141, v141
    v_exp_f32 v142, v142
    v_exp_f32 v143, v143
    v_cvt_pk_bf16_f32 v152, v128, v129
    v_cvt_pk_bf16_f32 v153, v130, v131
    v_cvt_pk_bf16_f32 v154, v132, v133
    v_cvt_pk_bf16_f32 v155, v134, v135
    v_cvt_pk_bf16_f32 v156, v136, v137
    v_cvt_pk_bf16_f32 v157, v138, v139
    v_cvt_pk_bf16_f32 v158, v140, v141
    v_cvt_pk_bf16_f32 v159, v142, v143
    v_mfma_f32_32x32x16_bf16 v[128:143], v[96:99], v[40:43], 0
    v_exp_f32 v112, v112
    v_exp_f32 v113, v113
    v_exp_f32 v114, v114
    v_mfma_f32_32x32x16_bf16 v[128:143], v[100:103], v[44:47], v[128:143]
    v_exp_f32 v115, v115
    v_exp_f32 v116, v116
    v_exp_f32 v117, v117
    v_mfma_f32_32x32x16_bf16 v[176:191], v[104:107], v[152:155], v[176:191]
    v_exp_f32 v118, v118
    v_exp_f32 v119, v119
    v_exp_f32 v120, v120
    v_mfma_f32_32x32x16_bf16 v[176:191], v[108:111], v[156:159], v[176:191]
    v_exp_f32 v121, v121
    v_exp_f32 v122, v122
    v_exp_f32 v123, v123
    v_exp_f32 v124, v124
    v_exp_f32 v125, v125
    v_exp_f32 v126, v126
    v_exp_f32 v127, v127
    v_cvt_pk_bf16_f32 v144, v112, v113
    v_cvt_pk_bf16_f32 v145, v114, v115
    v_cvt_pk_bf16_f32 v146, v116, v117
    v_cvt_pk_bf16_f32 v147, v118, v119
    v_cvt_pk_bf16_f32 v148, v120, v121
    v_cvt_pk_bf16_f32 v149, v122, v123
    v_cvt_pk_bf16_f32 v150, v124, v125
    v_cvt_pk_bf16_f32 v151, v126, v127
    s_waitcnt vmcnt(8)
    v_mfma_f32_32x32x16_bf16 v[112:127], v[48:51], v[16:19], 0
    v_exp_f32 v128, v128
    v_exp_f32 v129, v129
    v_exp_f32 v130, v130
    v_mfma_f32_32x32x16_bf16 v[112:127], v[52:55], v[20:23], v[112:127]
    v_exp_f32 v131, v131
    v_exp_f32 v132, v132
    v_exp_f32 v133, v133
    v_mfma_f32_32x32x16_bf16 v[192:207], v[104:107], v[144:147], v[192:207]
    v_exp_f32 v134, v134
    v_exp_f32 v135, v135
    v_exp_f32 v136, v136
    v_mfma_f32_32x32x16_bf16 v[192:207], v[108:111], v[148:151], v[192:207]
    v_exp_f32 v137, v137
    s_sub_u32 s41, s41, 1
    v_exp_f32 v138, v138
    v_exp_f32 v139, v139
    s_cmp_lg_u32 s41, 0
    v_exp_f32 v140, v140
    v_exp_f32 v141, v141
    v_exp_f32 v142, v142
    v_exp_f32 v143, v143
    v_cvt_pk_bf16_f32 v152, v128, v129
    v_cvt_pk_bf16_f32 v153, v130, v131
    v_cvt_pk_bf16_f32 v154, v132, v133
    v_cvt_pk_bf16_f32 v155, v134, v135
    v_cvt_pk_bf16_f32 v156, v136, v137
    v_cvt_pk_bf16_f32 v157, v138, v139
    v_cvt_pk_bf16_f32 v158, v140, v141
    v_cvt_pk_bf16_f32 v159, v142, v143
    s_cbranch_scc1 F_aloop
    s_nop 0
    v_mfma_f32_32x32x16_bf16 v[208:223], v[104:107], v[152:155], v[208:223]
    v_mfma_f32_32x32x16_bf16 v[208:223], v[108:111], v[156:159], v[208:223]
    s_nop 3
    ds_write_b128 v5, v[176:179] offset:0
    ds_write_b128 v5, v[180:183] offset:1024
    ds_write_b128 v5, v[184:187] offset:2048
    ds_write_b128 v5, v[188:191] offset:3072
    ds_write_b128 v6, v[192:195] offset:4096
    ds_write_b128 v6, v[196:199] offset:5120
    ds_write_b128 v6, v[200:203] offset:6144
    ds_write_b128 v6, v[204:207] offset:7168
    ds_write_b128 v7, v[208:211] offset:8192
    ds_write_b128 v7, v[212:215] offset:9216
    ds_write_b128 v7, v[216:219] offset:10240
    ds_write_b128 v7, v[220:223] offset:11264
    v_mov_b32 v10, 155672
    v_mov_b32 v11, 1
    s_mov_b64 exec, 1
    ds_add_u32 v10, v11
    s_mov_b64 exec, -1
    s_mul_i32 s42, s32, 12288
    v_add_u32 v4, s42, v2
    s_lshl_b32 s45, s37, 2
    s_add_u32 s45, s45, s32
    s_lshl_b32 s45, s45, 4
    s_add_u32 s45, s45, s36
    s_lshl_b32 s45, s45, 11
    s_add_u32 s45, s45, 14680064
    v_mov_b32 v10, 155672
    s_mov_b32 s43, 0x80000
    s_branch F_iw
F_iw_s:
    s_sleep 1
F_iw:
    ds_read_b32 v11, v10
    s_waitcnt lgkmcnt(0)
    v_readfirstlane_b32 s42, v11
    s_sub_u32 s43, s43, 1
    s_cselect_b32 s42, 4, s42
    s_cmp_lt_u32 s42, 4
    s_cbranch_scc1 F_iw_s
    ds_read_b128 v[176:179], v4 offset:0
    ds_read_b128 v[180:183], v4 offset:1024
    ds_read_b128 v[184:187], v4 offset:2048
    ds_read_b128 v[188:191], v4 offset:3072
    ds_read_b128 v[192:195], v4 offset:4096
    ds_read_b128 v[196:199], v4 offset:5120
    ds_read_b128 v[200:203], v4 offset:6144
    ds_read_b128 v[204:207], v4 offset:7168
    ds_read_b128 v[208:211], v4 offset:8192
    ds_read_b128 v[212:215], v4 offset:9216
    ds_read_b128 v[216:219], v4 offset:10240
    ds_read_b128 v[220:223], v4 offset:11264
    s_waitcnt lgkmcnt(8)
    v_pk_add_f32 v[160:161], v[160:161], v[176:177]
    v_pk_add_f32 v[162:163], v[162:163], v[178:179]
    v_pk_add_f32 v[164:165], v[164:165], v[180:181]
    v_pk_add_f32 v[166:167], v[166:167], v[182:183]
    v_pk_add_f32 v[168:169], v[168:169], v[184:185]
    v_pk_add_f32 v[170:171], v[170:171], v[186:187]
    v_pk_add_f32 v[172:173], v[172:173], v[188:189]
    v_pk_add_f32 v[174:175], v[174:175], v[190:191]
    s_waitcnt lgkmcnt(4)
    v_pk_add_f32 v[160:161], v[160:161], v[192:193]
    v_pk_add_f32 v[162:163], v[162:163], v[194:195]
    v_pk_add_f32 v[164:165], v[164:165], v[196:197]
    v_pk_add_f32 v[166:167], v[166:167], v[198:199]
    v_pk_add_f32 v[168:169], v[168:169], v[200:201]
    v_pk_add_f32 v[170:171], v[170:171], v[202:203]
    v_pk_add_f32 v[172:173], v[172:173], v[204:205]
    v_pk_add_f32 v[174:175], v[174:175], v[206:207]
    s_waitcnt lgkmcnt(0)
    v_pk_add_f32 v[160:161], v[160:161], v[208:209]
    v_pk_add_f32 v[162:163], v[162:163], v[210:211]
    v_pk_add_f32 v[164:165], v[164:165], v[212:213]
    v_pk_add_f32 v[166:167], v[166:167], v[214:215]
    v_pk_add_f32 v[168:169], v[168:169], v[216:217]
    v_pk_add_f32 v[170:171], v[170:171], v[218:219]
    v_pk_add_f32 v[172:173], v[172:173], v[220:221]
    v_pk_add_f32 v[174:175], v[174:175], v[222:223]
    v_add_f32 v6, abs(v160), abs(v161)
    v_add_f32 v6, v6, abs(v162)
    v_add_f32 v6, v6, abs(v163)
    v_add_f32 v6, v6, abs(v164)
    v_add_f32 v6, v6, abs(v165)
    v_add_f32 v6, v6, abs(v166)
    v_add_f32 v6, v6, abs(v167)
    v_add_f32 v6, v6, abs(v168)
    v_add_f32 v6, v6, abs(v169)
    v_add_f32 v6, v6, abs(v170)
    v_add_f32 v6, v6, abs(v171)
    v_add_f32 v6, v6, abs(v172)
    v_add_f32 v6, v6, abs(v173)
    v_add_f32 v6, v6, abs(v174)
    v_add_f32 v6, v6, abs(v175)
    v_cmp_lt_f32 vcc, 0x21800000, v172
    s_mov_b32 s42, vcc_hi
    v_cmp_gt_f32 vcc, 0x71800000, v6
    s_and_b32 vcc_hi, vcc_hi, s42
    s_cmp_eq_u64 vcc, -1
    s_cbranch_scc0 F_slow
F_fin:
    v_mov_b32 v6, v172
    v_mov_b32 v7, v172
    s_nop 1
    v_permlane32_swap_b32 v6, v7
    s_nop 0
    v_rcp_f32 v6, v7
    v_rcp_f32 v7, v7
    s_mov_b64 exec, s[52:53]
    v_mov_b64 v[172:173], 0
    v_mov_b64 v[174:175], 0
    s_mov_b64 exec, -1
    v_pk_mul_f32 v[160:161], v[160:161], v[6:7]
    v_pk_mul_f32 v[162:163], v[162:163], v[6:7]
    v_pk_mul_f32 v[164:165], v[164:165], v[6:7]
    v_pk_mul_f32 v[166:167], v[166:167], v[6:7]
    v_pk_mul_f32 v[168:169], v[168:169], v[6:7]
    v_pk_mul_f32 v[170:171], v[170:171], v[6:7]
    v_pk_mul_f32 v[172:173], v[172:173], v[6:7]
    v_pk_mul_f32 v[174:175], v[174:175], v[6:7]
    v_cvt_pk_bf16_f32 v112, v160, v161
    v_cvt_pk_bf16_f32 v113, v162, v163
    v_cvt_pk_bf16_f32 v114, v164, v165
    v_cvt_pk_bf16_f32 v115, v166, v167
    v_cvt_pk_bf16_f32 v116, v168, v169
    v_cvt_pk_bf16_f32 v117, v170, v171
    v_cvt_pk_bf16_f32 v118, v172, v173
    v_cvt_pk_bf16_f32 v119, v174, v175
    buffer_store_dwordx4 v[112:115], v2, s[28:31], s45 offen sc1
    buffer_store_dwordx4 v[116:119], v2, s[28:31], s45 offen offset:1024 sc1
    s_lshl_b32 s45, s37, 11
    s_lshl_b32 s42, s36, 7
    s_add_u32 s45, s45, s42
    s_add_u32 s45, s45, 17891328
    v_and_b32 v6, 15, v1
    v_lshrrev_b32 v4, 2, v6
    v_lshl_add_u32 v4, v3, 2, v4
    v_lshlrev_b32 v16, 7, v4
    v_bfe_u32 v4, v1, 4, 1
    v_lshl_add_u32 v16, v4, 5, v16
    v_and_b32 v4, 3, v6
    v_lshl_add_u32 v16, v4, 3, v16
    v_bfe_u32 v4, v6, 3, 1
    v_lshl_add_u32 v16, v4, 6, v16
    s_lshl_b32 s42, s15, 5
    v_xor_b32 v16, s42, v16
    v_xor_b32 v17, 64, v16
    v_mov_b64 v[96:97], 0
    v_mov_b64 v[98:99], 0
    s_nop 1
    v_mfma_f32_32x32x16_bf16 v[128:143], v[96:99], v[96:99], 0
    v_mfma_f32_32x32x16_bf16 v[144:159], v[96:99], v[96:99], 0
    v_mov_b32 v10, 155656
    v_mov_b32 v11, 1
    s_mov_b64 exec, 1
    ds_add_u32 v10, v11
    s_mov_b64 exec, -1
    v_mov_b32 v5, 1
    s_lshl_b32 s42, s32, 2
    s_add_u32 s45, s45, s42
    s_mov_b64 exec, 1
    s_waitcnt vmcnt(0)
    buffer_store_dword v5, v15, s[28:31], s45 offen sc1
    s_mov_b64 exec, -1
    s_cmp_ge_u32 s48, 7
    s_cbranch_scc1 F_end
    s_branch F_tail
F_slow:
    v_mov_b32 v6, 0xff800000
    s_mov_b32 s38, 0
    s_mov_b32 s39, 0
    s_mov_b64 exec, s[52:53]
    v_mov_b64 v[22:23], 0
    s_mov_b64 exec, -1
F_sl1:
    buffer_load_dwordx4 v[48:51], v2, s[4:7], s38 offen sc1
    buffer_load_dwordx4 v[52:55], v2, s[4:7], s38 offen offset:1024 sc1
    s_mov_b64 exec, s[50:51]
    buffer_load_dwordx4 v[56:59], v14, s[16:19], s39 offen sc1
    s_add_u32 s39, s39, 14336
    buffer_load_dwordx4 v[60:63], v14, s[16:19], s39 offen sc1
    s_mov_b64 exec, -1
    s_add_u32 s39, s39, 14336
    s_add_u32 s38, s38, 4096
    s_waitcnt vmcnt(0)
    v_mfma_f32_32x32x16_bf16 v[128:143], v[48:51], v[16:19], 0
    v_mfma_f32_32x32x16_bf16 v[128:143], v[52:55], v[20:23], v[128:143]
    s_nop 15
    v_max3_f32 v6, v6, v128, v129
    v_max3_f32 v6, v6, v130, v131
    v_max3_f32 v6, v6, v132, v133
    v_max3_f32 v6, v6, v134, v135
    v_max3_f32 v6, v6, v136, v137
    v_max3_f32 v6, v6, v138, v139
    v_max3_f32 v6, v6, v140, v141
    v_max3_f32 v6, v6, v142, v143
    s_cmp_lt_u32 s38, 262144
    s_cbranch_scc1 F_sl1
    v_mov_b32 v8, v6
    s_nop 1
    v_permlane32_swap_b32 v6, v8
    s_nop 0
    v_max_f32 v6, v6, v8
    s_mov_b64 exec, s[52:53]
    v_sub_f32 v6, 0, v6
    v_and_b32 v8, s46, v6
    v_sub_f32 v8, v6, v8
    v_lshrrev_b32 v6, 16, v6
    v_and_b32 v9, s46, v8
    v_or_b32 v22, v6, v9
    v_sub_f32 v8, v8, v9
    v_lshrrev_b32 v23, 16, v8
    s_mov_b64 exec, -1
    v_mov_b64 v[160:161], 0
    v_mov_b64 v[162:163], 0
    v_mov_b64 v[164:165], 0
    v_mov_b64 v[166:167], 0
    v_mov_b64 v[168:169], 0
    v_mov_b64 v[170:171], 0
    v_mov_b64 v[172:173], 0
    v_mov_b64 v[174:175], 0
    s_mov_b32 s38, 0
    s_mov_b32 s39, 0
F_sl2:
    buffer_load_dwordx4 v[48:51], v2, s[4:7], s38 offen sc1
    buffer_load_dwordx4 v[52:55], v2, s[4:7], s38 offen offset:1024 sc1
    s_mov_b64 exec, s[50:51]
    buffer_load_dwordx4 v[56:59], v14, s[16:19], s39 offen sc1
    s_add_u32 s39, s39, 14336
    buffer_load_dwordx4 v[60:63], v14, s[16:19], s39 offen sc1
    s_mov_b64 exec, -1
    s_add_u32 s39, s39, 14336
    s_add_u32 s38, s38, 4096
    s_waitcnt vmcnt(0)
    v_mfma_f32_32x32x16_bf16 v[128:143], v[48:51], v[16:19], 0
    v_mfma_f32_32x32x16_bf16 v[128:143], v[52:55], v[20:23], v[128:143]
    s_nop 15
    v_exp_f32 v128, v128
    v_exp_f32 v129, v129
    v_exp_f32 v130, v130
    v_exp_f32 v131, v131
    v_cvt_pk_bf16_f32 v144, v128, v129
    v_cvt_pk_bf16_f32 v145, v130, v131
    v_exp_f32 v132, v132
    v_exp_f32 v133, v133
    v_exp_f32 v134, v134
    v_exp_f32 v135, v135
    v_cvt_pk_bf16_f32 v146, v132, v133
    v_cvt_pk_bf16_f32 v147, v134, v135
    v_exp_f32 v136, v136
    v_exp_f32 v137, v137
    v_exp_f32 v138, v138
    v_exp_f32 v139, v139
    v_cvt_pk_bf16_f32 v148, v136, v137
    v_cvt_pk_bf16_f32 v149, v138, v139
    v_exp_f32 v140, v140
    v_exp_f32 v141, v141
    v_exp_f32 v142, v142
    v_exp_f32 v143, v143
    v_cvt_pk_bf16_f32 v150, v140, v141
    v_cvt_pk_bf16_f32 v151, v142, v143
    s_nop 1
    v_mfma_f32_32x32x16_bf16 v[160:175], v[56:59], v[144:147], v[160:175]
    v_mfma_f32_32x32x16_bf16 v[160:175], v[60:63], v[148:151], v[160:175]
    s_cmp_lt_u32 s38, 262144
    s_cbranch_scc1 F_sl2
    s_nop 15
    s_branch F_fin
P1_side:
    s_cmp_lg_u32 s41, 4
    s_cbranch_scc1 P1_s3
    s_lshl_b32 s49, s35, 12
    s_add_u32 s44, s44, 4
    s_addc_u32 s45, s45, 0
    s_setpc_b64 s[44:45]
P1_s3:
    s_cmp_lg_u32 s41, 3
    s_cbranch_scc1 P1_s2
    s_mov_b64 s[16:17], s[24:25]
    s_mov_b32 s18, s26
    v_mov_b32 v52, v9
    v_mov_b32 v53, v10
    s_mov_b32 s60, 8192
    s_mov_b32 s61, 8192
    s_mov_b32 s62, 57344
    s_mov_b32 s63, 57344
    s_add_u32 s49, s53, 16384
    s_add_u32 s36, s52, 1032192
    s_cmp_ge_u32 s36, 1605632
    s_cselect_b32 s13, 1605632, 0
    s_sub_u32 s36, s36, s13
    s_add_u32 s44, s44, 4
    s_addc_u32 s45, s45, 0
    s_setpc_b64 s[44:45]
P1_s2:
    s_cmp_lg_u32 s41, 2
    s_cbranch_scc1 P1_s1
    s_mov_b32 s49, 0x30000
    s_mov_b32 s36, 0x40000000
    s_mov_b32 s40, 0x34000
    s_mov_b32 s22, 0
    s_add_u32 s44, s44, 4
    s_addc_u32 s45, s45, 0
    s_setpc_b64 s[44:45]
P1_s1:
    s_add_u32 s49, s53, 32768
    s_add_u32 s36, s52, 1146880
    s_cmp_ge_u32 s36, 1605632
    s_cselect_b32 s13, 1605632, 0
    s_sub_u32 s36, s36, s13
    s_add_u32 s44, s44, 4
    s_addc_u32 s45, s45, 0
    s_setpc_b64 s[44:45]
P1_auxA:
    v_and_b32 v12, 0x1f0, v2
    s_lshl_b32 s42, s35, 9
    s_add_u32 s42, s42, 155712
    v_add_u32 v13, s42, v12
    s_lshl_b32 s42, s35, 7
    s_add_u32 s42, s42, 159296
    v_lshrrev_b32 v14, 2, v12
    v_add_u32 v14, s42, v14
    v_lshl_add_u32 v15, v3, 4, s42
    v_add_u32 v12, 157760, v12
    v_mov_b64 v[188:189], 0
    v_mov_b64 v[190:191], 0
    s_waitcnt vmcnt(12) lgkmcnt(0)
    s_barrier
    s_add_u32 s49, s53, 131072
    s_add_u32 s36, s52, 1376256
    s_cmp_ge_u32 s36, 1605632
    s_cselect_b32 s13, 1605632, 0
    s_sub_u32 s36, s36, s13
    s_mov_b32 m0, s49
    s_add_u32 s49, s49, s60
    buffer_load_dwordx4 v52, s[16:19], s36 offen lds
    buffer_load_dwordx4 v53, s[16:19], s36 offen offset:1024 lds
    s_add_u32 s36, s36, s62
    s_mov_b32 m0, s49
    s_add_u32 s49, s49, s61
    buffer_load_dwordx4 v52, s[16:19], s36 offen lds
    buffer_load_dwordx4 v53, s[16:19], s36 offen offset:1024 lds
    s_add_u32 s36, s36, s63
    v_mov_b32 v16, 155684
    s_mov_b32 s43, 0x100000
P1_aw:
    ds_read_b32 v17, v16
    s_waitcnt lgkmcnt(0)
    v_readfirstlane_b32 s42, v17
    s_sub_u32 s43, s43, 1
    s_cselect_b32 s42, 1, s42
    s_cmp_eq_u32 s42, 1
    s_cbranch_scc1 P1_aw_ok
    s_sleep 2
    s_branch P1_aw
P1_aw_ok:
    s_mov_b32 exec_hi, 0
    ds_read_b128 v[188:191], v13
    s_mov_b32 exec_hi, -1
    ds_read_b128 v[176:179], v12 offset:0
    ds_read_b128 v[180:183], v12 offset:512
    ds_read_b128 v[184:187], v12 offset:1024
    ds_read_b32 v4, v14
    ds_read_b128 v[192:195], v15 offset:0
    ds_read_b128 v[196:199], v15 offset:32
    ds_read_b128 v[200:203], v15 offset:64
    ds_read_b128 v[204:207], v15 offset:96
    s_waitcnt lgkmcnt(0)
    s_add_u32 s44, s44, 4
    s_addc_u32 s45, s45, 0
    s_setpc_b64 s[44:45]
P1_sideBq:
    s_cmp_le_u32 s41, 8
    s_cbranch_scc1 P1_sbr
P1_sideB:
    s_cmp_le_u32 s41, 4
    s_cbranch_scc1 P1_auxB
    s_movk_i32 s43, 0x2000
P1_sb0:
    s_cmp_lg_u32 s41, 8
    s_cbranch_scc1 P1_sbn
    s_waitcnt vmcnt(0)
P1_sbn:
    s_getreg_b32 s42, hwreg(HW_REG_IB_STS)
    s_and_b32 s42, s42, 0x00c0000f
    s_cbranch_scc1 P1_sbr
    v_readfirstlane_b32 s42, v62
    s_cmp_eq_u32 s42, 1
    s_cbranch_scc1 P1_sbd
    buffer_load_dwordx2 v[62:63], v54, s[56:59], 0 offen offset:128 sc1
    s_min_u32 s53, s53, 9
P1_sba:
    s_cmp_lg_u32 s41, 8
    s_cbranch_scc1 P1_sbr
    s_sub_u32 s43, s43, 1
    s_cbranch_scc0 P1_sb0
    s_branch P1_sbw
P1_sbr:
    s_add_u32 s44, s44, 4
    s_addc_u32 s45, s45, 0
    s_setpc_b64 s[44:45]
P1_sbd:
    v_max3_u32 v16, v28, v29, v30
    v_max3_u32 v16, v16, v31, v32
    v_max3_u32 v16, v16, v33, v34
    v_max3_u32 v16, v16, v35, v36
    v_max3_u32 v16, v16, v37, v38
    v_max3_u32 v16, v16, v39, v40
    v_max3_u32 v16, v16, v41, v42
    v_max_u32 v16, v16, v43
    v_cmp_eq_u32 vcc, -1, v16
    s_cbranch_vccz P1_sbw
    s_lshl_b32 s42, s33, 11
    s_add_u32 s42, s42, 16777216
    buffer_load_dwordx4 v[28:31], v2, s[28:31], s42 offen sc1
    buffer_load_dwordx4 v[32:35], v2, s[28:31], s42 offen offset:1024 sc1
    s_mul_i32 s42, s34, 1536
    s_add_u32 s42, s42, 16842752
    buffer_load_dwordx4 v[36:39], v2, s[28:31], s42 offen sc1
    s_mov_b32 exec_hi, 0
    buffer_load_dwordx4 v[40:43], v2, s[28:31], s42 offen offset:1024 sc1
    s_lshl_b32 s42, s33, 9
    s_add_u32 s42, s42, 16809472
    s_not_b64 exec, exec
    buffer_load_dwordx4 v[40:43], v2, s[28:31], s42 offen sc1
    s_mov_b64 exec, -1
    s_branch P1_sba
P1_sbw:
    v_add_u32 v16, 155712, v2
    ds_write_b128 v16, v[28:31] offset:0
    ds_write_b128 v16, v[32:35] offset:1024
    ds_write_b128 v16, v[36:39] offset:2048
    ds_write_b128 v16, v[40:43] offset:3072
    v_mov_b32 v16, 155684
    v_mov_b32 v17, 1
    ds_write_b32 v16, v17
    s_movk_i32 s53, 4
    s_add_u32 s44, s44, 4
    s_addc_u32 s45, s45, 0
    s_setpc_b64 s[44:45]
P1_auxB:
    s_mov_b32 s53, 0
    v_and_b32 v12, 0x1f0, v2
    s_lshl_b32 s42, s34, 1
    s_lshr_b32 s43, s35, 1
    s_add_u32 s42, s42, s43
    s_lshl_b32 s42, s42, 10
    s_add_u32 s42, s42, 16864256
    s_add_u32 s43, s42, 28672
    buffer_load_dwordx4 v[112:115], v12, s[28:31], s42 offen offset:0 sc1
    buffer_load_dwordx4 v[116:119], v12, s[28:31], s42 offen offset:512 sc1
    buffer_load_dwordx4 v[120:123], v12, s[28:31], s43 offen offset:0 sc1
    buffer_load_dwordx4 v[124:127], v12, s[28:31], s43 offen offset:512 sc1
    s_and_b32 s43, s35, 1
    s_lshl_b32 s42, s43, 10
    s_add_u32 s42, s42, 155712
    v_add_u32 v13, s42, v12
    s_lshl_b32 s42, s43, 8
    s_add_u32 s42, s42, 159296
    v_lshrrev_b32 v14, 2, v12
    v_add_u32 v14, s42, v14
    v_mov_b64 v[28:29], 0
    v_mov_b64 v[30:31], 0
    v_mov_b64 v[32:33], 0
    v_mov_b64 v[34:35], 0
    ds_read_b32 v4, v14
    ds_read_b32 v5, v14 offset:128
    s_mov_b32 exec_hi, 0
    ds_read_b128 v[28:31], v13 offset:0
    ds_read_b128 v[32:35], v13 offset:512
    s_mov_b32 exec_hi, -1
    s_add_u32 s44, s44, 4
    s_addc_u32 s45, s45, 0
    s_setpc_b64 s[44:45]
P1_B:
    s_mov_b32 s14, 1987475062
    s_mov_b32 s15, 125317654
    s_mov_b32 s55, 589823
    s_mov_b32 s41, 14
    v_mov_b32 v28, -1
    s_cmp_eq_u32 s32, 4
    s_cselect_b32 s53, 12, 4
    v_and_b32 v13, 31, v1
    v_bfe_u32 v14, v1, 1, 3
    v_xor_b32 v14, v14, v3
    v_lshlrev_b32 v14, 4, v14
    v_lshl_add_u32 v48, v13, 7, v14
    s_and_b32 s42, s35, 1
    s_lshl_b32 s42, s42, 13
    v_add_u32 v48, s42, v48
    v_xor_b32 v49, 32, v48
    v_xor_b32 v50, 64, v48
    v_xor_b32 v51, 96, v48
    v_and_b32 v12, 15, v1
    v_lshrrev_b32 v13, 2, v12
    v_lshl_add_u32 v14, v3, 3, v13
    v_bfe_u32 v13, v1, 4, 1
    v_lshlrev_b32 v15, 5, v13
    v_and_b32 v13, 3, v12
    v_lshl_add_u32 v15, v13, 3, v15
    s_mov_b32 s47, 16384
    v_lshlrev_b32 v7, 7, v14
    v_add_u32 v7, v7, v15
    v_bfe_u32 v13, v12, 3, 1
    v_lshl_add_u32 v7, v13, 6, v7
    v_xor_b32 v8, 64, v7
    s_lshr_b32 s42, s35, 1
    s_lshl_b32 s42, s42, 12
    v_add_u32 v9, s42, v7
    v_add_u32 v10, s42, v8
    v_add_u32 v7, 98304, v9
    v_add_u32 v8, 98304, v10
    v_mfma_f32_32x32x16_bf16 v[128:143], v[20:23], v[20:23], 0
    v_mfma_f32_32x32x16_bf16 v[144:159], v[20:23], v[20:23], 0
    v_mfma_f32_32x32x16_bf16 v[160:175], v[20:23], v[20:23], 0
    v_mfma_f32_32x32x16_bf16 v[176:191], v[20:23], v[20:23], 0
    v_mfma_f32_32x32x16_bf16 v[192:207], v[20:23], v[20:23], 0
    v_mfma_f32_32x32x16_bf16 v[208:223], v[20:23], v[20:23], 0
    v_mfma_f32_32x32x16_bf16 v[224:239], v[20:23], v[20:23], 0
    v_mfma_f32_32x32x16_bf16 v[240:255], v[20:23], v[20:23], 0
    s_add_u32 s49, s49, 16384
    s_mov_b32 m0, s49
    s_add_u32 s49, s49, s60
    buffer_load_dwordx4 v52, s[16:19], s36 offen lds
    buffer_load_dwordx4 v53, s[16:19], s36 offen offset:1024 lds
    s_add_u32 s36, s36, s62
    s_mov_b32 m0, s49
    s_add_u32 s49, s49, s61
    buffer_load_dwordx4 v52, s[16:19], s36 offen lds
    buffer_load_dwordx4 v53, s[16:19], s36 offen offset:1024 lds
    s_add_u32 s36, s36, s63
    s_waitcnt vmcnt(4)
    s_barrier
    ds_read_b128 v[96:99], v48
    ds_read_b128 v[100:103], v48 offset:4096
    ds_read_b64_tr_b16 v[64:65], v7 offset:0
    ds_read_b64_tr_b16 v[66:67], v7 offset:512
    ds_read_b64_tr_b16 v[68:69], v8 offset:0
    ds_read_b64_tr_b16 v[70:71], v8 offset:512
    ds_read_b64_tr_b16 v[72:73], v7 offset:2048
    ds_read_b64_tr_b16 v[74:75], v7 offset:2560
    ds_read_b64_tr_b16 v[76:77], v8 offset:2048
    ds_read_b64_tr_b16 v[78:79], v8 offset:2560
    s_waitcnt vmcnt(0) lgkmcnt(0)
P1_loopB:
    s_bitcmp0_b32 s55, 0
    s_cbranch_scc1 P1_loopB_b0
    s_barrier
P1_loopB_b0:
    v_mfma_f32_32x32x16_bf16 v[128:143], v[64:67], v[96:99], v[128:143]
    ds_read_b128 v[104:107], v49 offset:0
    ds_read_b64_tr_b16 v[80:81], v7 offset:8192
    v_mfma_f32_32x32x16_bf16 v[192:207], v[64:67], v[100:103], v[192:207]
    ds_read_b64_tr_b16 v[82:83], v7 offset:8704
    ds_read_b128 v[108:111], v49 offset:4096
    v_mfma_f32_32x32x16_bf16 v[144:159], v[68:71], v[96:99], v[144:159]
    ds_read_b64_tr_b16 v[84:85], v8 offset:8192
    ds_read_b64_tr_b16 v[86:87], v8 offset:8704
    v_mfma_f32_32x32x16_bf16 v[208:223], v[68:71], v[100:103], v[208:223]
    ds_read_b64_tr_b16 v[88:89], v7 offset:10240
    ds_read_b64_tr_b16 v[90:91], v7 offset:10752
    v_mfma_f32_32x32x16_bf16 v[160:175], v[72:75], v[96:99], v[160:175]
    ds_read_b64_tr_b16 v[92:93], v8 offset:10240
    ds_read_b64_tr_b16 v[94:95], v8 offset:10752
    v_mfma_f32_32x32x16_bf16 v[224:239], v[72:75], v[100:103], v[224:239]
    s_bitcmp1_b32 s41, 0
    s_cselect_b32 s43, 16384, 0
    s_cmp_eq_u32 s41, 3
    s_cselect_b32 s43, 4294885376, s43
    v_xor_b32 v48, 64, v48
    v_add_u32 v48, s43, v48
    v_mfma_f32_32x32x16_bf16 v[176:191], v[76:79], v[96:99], v[176:191]
    v_xor_b32 v49, 32, v48
    s_lshr_b64 s[14:15], s[14:15], 4
    s_and_b32 s43, s14, 15
    s_lshl_b32 s43, s43, 14
    v_add_u32 v7, s43, v9
    v_add_u32 v8, s43, v10
    v_mfma_f32_32x32x16_bf16 v[240:255], v[76:79], v[100:103], v[240:255]
    s_waitcnt lgkmcnt(0)
    s_bitcmp0_b32 s55, 1
    s_cbranch_scc1 P1_loopB_b1
    s_barrier
P1_loopB_b1:
    v_mfma_f32_32x32x16_bf16 v[128:143], v[80:83], v[104:107], v[128:143]
    s_cmp_gt_u32 s41, s53
    s_cbranch_scc1 P1_loopB_n1
    s_getpc_b64 s[44:45]
    s_branch P1_sideB
P1_loopB_n1:
    ds_read_b128 v[96:99], v48 offset:0
    ds_read_b64_tr_b16 v[64:65], v7 offset:0
    v_mfma_f32_32x32x16_bf16 v[192:207], v[80:83], v[108:111], v[192:207]
    ds_read_b64_tr_b16 v[66:67], v7 offset:512
    ds_read_b128 v[100:103], v48 offset:4096
    v_mfma_f32_32x32x16_bf16 v[144:159], v[84:87], v[104:107], v[144:159]
    ds_read_b64_tr_b16 v[68:69], v8 offset:0
    ds_read_b64_tr_b16 v[70:71], v8 offset:512
    v_mfma_f32_32x32x16_bf16 v[208:223], v[84:87], v[108:111], v[208:223]
    ds_read_b64_tr_b16 v[72:73], v7 offset:2048
    ds_read_b64_tr_b16 v[74:75], v7 offset:2560
    v_mfma_f32_32x32x16_bf16 v[160:175], v[88:91], v[104:107], v[160:175]
    ds_read_b64_tr_b16 v[76:77], v8 offset:2048
    ds_read_b64_tr_b16 v[78:79], v8 offset:2560
    v_mfma_f32_32x32x16_bf16 v[224:239], v[88:91], v[108:111], v[224:239]
    s_lshr_b32 s55, s55, 2
    v_mfma_f32_32x32x16_bf16 v[176:191], v[92:95], v[104:107], v[176:191]
    s_sub_u32 s41, s41, 1
    s_cmp_lg_u32 s41, 0
    v_mfma_f32_32x32x16_bf16 v[240:255], v[92:95], v[108:111], v[240:255]
    s_waitcnt lgkmcnt(0)
    s_cbranch_scc1 P1_loopB
    s_mov_b32 s55, 0x2000
P1_bchk:
    s_waitcnt vmcnt(0) lgkmcnt(0)
    v_max3_u32 v16, v112, v113, v114
    v_max3_u32 v16, v16, v115, v116
    v_max3_u32 v16, v16, v117, v118
    v_max3_u32 v16, v16, v119, v120
    v_max3_u32 v16, v16, v121, v122
    v_max3_u32 v16, v16, v123, v124
    v_max3_u32 v16, v16, v125, v126
    v_max_u32 v16, v16, v127
    v_cmp_eq_u32 vcc, -1, v16
    s_cbranch_vccz P1_bok
    s_sub_u32 s55, s55, 1
    s_cbranch_scc1 P1_bok
    s_sleep 8
    s_getpc_b64 s[44:45]
    s_branch P1_auxB
    s_branch P1_bchk
P1_bok:
    v_mfma_f32_32x32x16_bf16 v[128:143], v[112:115], v[28:31], v[128:143]
    v_mfma_f32_32x32x16_bf16 v[192:207], v[112:115], v[32:35], v[192:207]
    v_mfma_f32_32x32x16_bf16 v[144:159], v[116:119], v[28:31], v[144:159]
    v_mfma_f32_32x32x16_bf16 v[208:223], v[116:119], v[32:35], v[208:223]
    v_mfma_f32_32x32x16_bf16 v[160:175], v[120:123], v[28:31], v[160:175]
    v_mfma_f32_32x32x16_bf16 v[224:239], v[120:123], v[32:35], v[224:239]
    v_mfma_f32_32x32x16_bf16 v[176:191], v[124:127], v[28:31], v[176:191]
    v_mfma_f32_32x32x16_bf16 v[240:255], v[124:127], v[32:35], v[240:255]
    s_setprio 2
    s_and_b32 s43, s35, 1
    s_lshl_b32 s43, s43, 1
    s_lshl_b32 s44, s33, 2
    s_add_u32 s43, s43, s44
    s_mul_i32 s43, s43, 112
    s_lshl_b32 s44, s34, 3
    s_add_u32 s43, s43, s44
    s_lshr_b32 s44, s35, 1
    s_lshl_b32 s44, s44, 2
    s_add_u32 s43, s43, s44
    s_lshl_b32 s43, s43, 10
    s_add_u32 s43, s43, 6291456
    s_add_u32 s44, s43, 114688
    v_mul_f32 v32, v4, v4
    v_mul_f32 v28, 0xc0135761, v4
    v_mul_f32 v30, v32, v4
    v_mul_f32 v30, 0xbdd2d3e8, v30
    v_rcp_f32 v32, v32
    v_mov_b32 v29, v28
    v_mov_b32 v31, v30
    v_mov_b32 v33, v32
    v_mul_f32 v38, v5, v5
    v_mul_f32 v34, 0xc0135761, v5
    v_mul_f32 v36, v38, v5
    v_mul_f32 v36, 0xbdd2d3e8, v36
    v_rcp_f32 v38, v38
    v_mov_b32 v35, v34
    v_mov_b32 v37, v36
    v_mov_b32 v39, v38
    v_pk_mul_f32 v[12:13], v[128:129], v[128:129]
    v_pk_mul_f32 v[14:15], v[130:131], v[130:131]
    v_pk_mul_f32 v[16:17], v[132:133], v[132:133]
    v_pk_mul_f32 v[18:19], v[134:135], v[134:135]
    v_pk_fma_f32 v[12:13], v[12:13], v[30:31], v[28:29]
    v_pk_fma_f32 v[14:15], v[14:15], v[30:31], v[28:29]
    v_pk_fma_f32 v[16:17], v[16:17], v[30:31], v[28:29]
    v_pk_fma_f32 v[18:19], v[18:19], v[30:31], v[28:29]
    v_pk_mul_f32 v[12:13], v[12:13], v[128:129]
    v_pk_mul_f32 v[14:15], v[14:15], v[130:131]
    v_pk_mul_f32 v[16:17], v[16:17], v[132:133]
    v_pk_mul_f32 v[18:19], v[18:19], v[134:135]
    v_exp_f32 v12, v12
    v_exp_f32 v13, v13
    v_exp_f32 v14, v14
    v_exp_f32 v15, v15
    v_exp_f32 v16, v16
    v_exp_f32 v17, v17
    v_exp_f32 v18, v18
    v_exp_f32 v19, v19
    v_pk_mul_f32 v[160:161], v[160:161], v[128:129]
    v_pk_mul_f32 v[162:163], v[162:163], v[130:131]
    v_pk_mul_f32 v[164:165], v[164:165], v[132:133]
    v_pk_mul_f32 v[166:167], v[166:167], v[134:135]
    v_pk_fma_f32 v[12:13], v[12:13], v[32:33], v[32:33]
    v_pk_fma_f32 v[14:15], v[14:15], v[32:33], v[32:33]
    v_pk_fma_f32 v[16:17], v[16:17], v[32:33], v[32:33]
    v_pk_fma_f32 v[18:19], v[18:19], v[32:33], v[32:33]
    v_rcp_f32 v12, v12
    v_rcp_f32 v13, v13
    v_rcp_f32 v14, v14
    v_rcp_f32 v15, v15
    v_rcp_f32 v16, v16
    v_rcp_f32 v17, v17
    v_rcp_f32 v18, v18
    v_rcp_f32 v19, v19
    s_nop 0
    v_pk_mul_f32 v[160:161], v[160:161], v[12:13]
    v_pk_mul_f32 v[162:163], v[162:163], v[14:15]
    v_pk_mul_f32 v[164:165], v[164:165], v[16:17]
    v_pk_mul_f32 v[166:167], v[166:167], v[18:19]
    v_cvt_pk_bf16_f32 v64, v160, v161
    v_cvt_pk_bf16_f32 v65, v162, v163
    v_cvt_pk_bf16_f32 v66, v164, v165
    v_cvt_pk_bf16_f32 v67, v166, v167
    v_pk_mul_f32 v[12:13], v[136:137], v[136:137]
    v_pk_mul_f32 v[14:15], v[138:139], v[138:139]
    v_pk_mul_f32 v[16:17], v[140:141], v[140:141]
    v_pk_mul_f32 v[18:19], v[142:143], v[142:143]
    v_pk_fma_f32 v[12:13], v[12:13], v[30:31], v[28:29]
    v_pk_fma_f32 v[14:15], v[14:15], v[30:31], v[28:29]
    v_pk_fma_f32 v[16:17], v[16:17], v[30:31], v[28:29]
    v_pk_fma_f32 v[18:19], v[18:19], v[30:31], v[28:29]
    v_pk_mul_f32 v[12:13], v[12:13], v[136:137]
    v_pk_mul_f32 v[14:15], v[14:15], v[138:139]
    v_pk_mul_f32 v[16:17], v[16:17], v[140:141]
    v_pk_mul_f32 v[18:19], v[18:19], v[142:143]
    v_exp_f32 v12, v12
    v_exp_f32 v13, v13
    v_exp_f32 v14, v14
    v_exp_f32 v15, v15
    v_exp_f32 v16, v16
    v_exp_f32 v17, v17
    v_exp_f32 v18, v18
    v_exp_f32 v19, v19
    v_pk_mul_f32 v[168:169], v[168:169], v[136:137]
    v_pk_mul_f32 v[170:171], v[170:171], v[138:139]
    v_pk_mul_f32 v[172:173], v[172:173], v[140:141]
    v_pk_mul_f32 v[174:175], v[174:175], v[142:143]
    v_pk_fma_f32 v[12:13], v[12:13], v[32:33], v[32:33]
    v_pk_fma_f32 v[14:15], v[14:15], v[32:33], v[32:33]
    v_pk_fma_f32 v[16:17], v[16:17], v[32:33], v[32:33]
    v_pk_fma_f32 v[18:19], v[18:19], v[32:33], v[32:33]
    v_rcp_f32 v12, v12
    v_rcp_f32 v13, v13
    v_rcp_f32 v14, v14
    v_rcp_f32 v15, v15
    v_rcp_f32 v16, v16
    v_rcp_f32 v17, v17
    v_rcp_f32 v18, v18
    v_rcp_f32 v19, v19
    s_nop 0
    v_pk_mul_f32 v[168:169], v[168:169], v[12:13]
    v_pk_mul_f32 v[170:171], v[170:171], v[14:15]
    v_pk_mul_f32 v[172:173], v[172:173], v[16:17]
    v_pk_mul_f32 v[174:175], v[174:175], v[18:19]
    v_cvt_pk_bf16_f32 v68, v168, v169
    v_cvt_pk_bf16_f32 v69, v170, v171
    v_cvt_pk_bf16_f32 v70, v172, v173
    v_cvt_pk_bf16_f32 v71, v174, v175
    v_pk_mul_f32 v[12:13], v[144:145], v[144:145]
    v_pk_mul_f32 v[14:15], v[146:147], v[146:147]
    v_pk_mul_f32 v[16:17], v[148:149], v[148:149]
    v_pk_mul_f32 v[18:19], v[150:151], v[150:151]
    v_pk_fma_f32 v[12:13], v[12:13], v[30:31], v[28:29]
    v_pk_fma_f32 v[14:15], v[14:15], v[30:31], v[28:29]
    v_pk_fma_f32 v[16:17], v[16:17], v[30:31], v[28:29]
    v_pk_fma_f32 v[18:19], v[18:19], v[30:31], v[28:29]
    v_pk_mul_f32 v[12:13], v[12:13], v[144:145]
    v_pk_mul_f32 v[14:15], v[14:15], v[146:147]
    v_pk_mul_f32 v[16:17], v[16:17], v[148:149]
    v_pk_mul_f32 v[18:19], v[18:19], v[150:151]
    v_exp_f32 v12, v12
    v_exp_f32 v13, v13
    v_exp_f32 v14, v14
    v_exp_f32 v15, v15
    v_exp_f32 v16, v16
    v_exp_f32 v17, v17
    v_exp_f32 v18, v18
    v_exp_f32 v19, v19
    v_pk_mul_f32 v[176:177], v[176:177], v[144:145]
    v_pk_mul_f32 v[178:179], v[178:179], v[146:147]
    v_pk_mul_f32 v[180:181], v[180:181], v[148:149]
    v_pk_mul_f32 v[182:183], v[182:183], v[150:151]
    v_pk_fma_f32 v[12:13], v[12:13], v[32:33], v[32:33]
    v_pk_fma_f32 v[14:15], v[14:15], v[32:33], v[32:33]
    v_pk_fma_f32 v[16:17], v[16:17], v[32:33], v[32:33]
    v_pk_fma_f32 v[18:19], v[18:19], v[32:33], v[32:33]
    v_rcp_f32 v12, v12
    v_rcp_f32 v13, v13
    v_rcp_f32 v14, v14
    v_rcp_f32 v15, v15
    v_rcp_f32 v16, v16
    v_rcp_f32 v17, v17
    v_rcp_f32 v18, v18
    v_rcp_f32 v19, v19
    s_nop 0
    v_pk_mul_f32 v[176:177], v[176:177], v[12:13]
    v_pk_mul_f32 v[178:179], v[178:179], v[14:15]
    v_pk_mul_f32 v[180:181], v[180:181], v[16:17]
    v_pk_mul_f32 v[182:183], v[182:183], v[18:19]
    v_cvt_pk_bf16_f32 v72, v176, v177
    v_cvt_pk_bf16_f32 v73, v178, v179
    v_cvt_pk_bf16_f32 v74, v180, v181
    v_cvt_pk_bf16_f32 v75, v182, v183
    v_pk_mul_f32 v[12:13], v[152:153], v[152:153]
    v_pk_mul_f32 v[14:15], v[154:155], v[154:155]
    v_pk_mul_f32 v[16:17], v[156:157], v[156:157]
    v_pk_mul_f32 v[18:19], v[158:159], v[158:159]
    v_pk_fma_f32 v[12:13], v[12:13], v[30:31], v[28:29]
    v_pk_fma_f32 v[14:15], v[14:15], v[30:31], v[28:29]
    v_pk_fma_f32 v[16:17], v[16:17], v[30:31], v[28:29]
    v_pk_fma_f32 v[18:19], v[18:19], v[30:31], v[28:29]
    v_pk_mul_f32 v[12:13], v[12:13], v[152:153]
    v_pk_mul_f32 v[14:15], v[14:15], v[154:155]
    v_pk_mul_f32 v[16:17], v[16:17], v[156:157]
    v_pk_mul_f32 v[18:19], v[18:19], v[158:159]
    v_exp_f32 v12, v12
    v_exp_f32 v13, v13
    v_exp_f32 v14, v14
    v_exp_f32 v15, v15
    v_exp_f32 v16, v16
    v_exp_f32 v17, v17
    v_exp_f32 v18, v18
    v_exp_f32 v19, v19
    v_pk_mul_f32 v[184:185], v[184:185], v[152:153]
    v_pk_mul_f32 v[186:187], v[186:187], v[154:155]
    v_pk_mul_f32 v[188:189], v[188:189], v[156:157]
    v_pk_mul_f32 v[190:191], v[190:191], v[158:159]
    v_pk_fma_f32 v[12:13], v[12:13], v[32:33], v[32:33]
    v_pk_fma_f32 v[14:15], v[14:15], v[32:33], v[32:33]
    v_pk_fma_f32 v[16:17], v[16:17], v[32:33], v[32:33]
    v_pk_fma_f32 v[18:19], v[18:19], v[32:33], v[32:33]
    v_rcp_f32 v12, v12
    v_rcp_f32 v13, v13
    v_rcp_f32 v14, v14
    v_rcp_f32 v15, v15
    v_rcp_f32 v16, v16
    v_rcp_f32 v17, v17
    v_rcp_f32 v18, v18
    v_rcp_f32 v19, v19
    s_nop 0
    v_pk_mul_f32 v[184:185], v[184:185], v[12:13]
    v_pk_mul_f32 v[186:187], v[186:187], v[14:15]
    v_pk_mul_f32 v[188:189], v[188:189], v[16:17]
    v_pk_mul_f32 v[190:191], v[190:191], v[18:19]
    v_cvt_pk_bf16_f32 v76, v184, v185
    v_cvt_pk_bf16_f32 v77, v186, v187
    v_cvt_pk_bf16_f32 v78, v188, v189
    v_cvt_pk_bf16_f32 v79, v190, v191
    v_pk_mul_f32 v[12:13], v[192:193], v[192:193]
    v_pk_mul_f32 v[14:15], v[194:195], v[194:195]
    v_pk_mul_f32 v[16:17], v[196:197], v[196:197]
    v_pk_mul_f32 v[18:19], v[198:199], v[198:199]
    v_pk_fma_f32 v[12:13], v[12:13], v[36:37], v[34:35]
    v_pk_fma_f32 v[14:15], v[14:15], v[36:37], v[34:35]
    v_pk_fma_f32 v[16:17], v[16:17], v[36:37], v[34:35]
    v_pk_fma_f32 v[18:19], v[18:19], v[36:37], v[34:35]
    v_pk_mul_f32 v[12:13], v[12:13], v[192:193]
    v_pk_mul_f32 v[14:15], v[14:15], v[194:195]
    v_pk_mul_f32 v[16:17], v[16:17], v[196:197]
    v_pk_mul_f32 v[18:19], v[18:19], v[198:199]
    v_exp_f32 v12, v12
    v_exp_f32 v13, v13
    v_exp_f32 v14, v14
    v_exp_f32 v15, v15
    v_exp_f32 v16, v16
    v_exp_f32 v17, v17
    v_exp_f32 v18, v18
    v_exp_f32 v19, v19
    v_pk_mul_f32 v[224:225], v[224:225], v[192:193]
    v_pk_mul_f32 v[226:227], v[226:227], v[194:195]
    v_pk_mul_f32 v[228:229], v[228:229], v[196:197]
    v_pk_mul_f32 v[230:231], v[230:231], v[198:199]
    v_pk_fma_f32 v[12:13], v[12:13], v[38:39], v[38:39]
    v_pk_fma_f32 v[14:15], v[14:15], v[38:39], v[38:39]
    v_pk_fma_f32 v[16:17], v[16:17], v[38:39], v[38:39]
    v_pk_fma_f32 v[18:19], v[18:19], v[38:39], v[38:39]
    v_rcp_f32 v12, v12
    v_rcp_f32 v13, v13
    v_rcp_f32 v14, v14
    v_rcp_f32 v15, v15
    v_rcp_f32 v16, v16
    v_rcp_f32 v17, v17
    v_rcp_f32 v18, v18
    v_rcp_f32 v19, v19
    s_nop 0
    v_pk_mul_f32 v[224:225], v[224:225], v[12:13]
    v_pk_mul_f32 v[226:227], v[226:227], v[14:15]
    v_pk_mul_f32 v[228:229], v[228:229], v[16:17]
    v_pk_mul_f32 v[230:231], v[230:231], v[18:19]
    v_cvt_pk_bf16_f32 v80, v224, v225
    v_cvt_pk_bf16_f32 v81, v226, v227
    v_cvt_pk_bf16_f32 v82, v228, v229
    v_cvt_pk_bf16_f32 v83, v230, v231
    v_pk_mul_f32 v[12:13], v[200:201], v[200:201]
    v_pk_mul_f32 v[14:15], v[202:203], v[202:203]
    v_pk_mul_f32 v[16:17], v[204:205], v[204:205]
    v_pk_mul_f32 v[18:19], v[206:207], v[206:207]
    v_pk_fma_f32 v[12:13], v[12:13], v[36:37], v[34:35]
    v_pk_fma_f32 v[14:15], v[14:15], v[36:37], v[34:35]
    v_pk_fma_f32 v[16:17], v[16:17], v[36:37], v[34:35]
    v_pk_fma_f32 v[18:19], v[18:19], v[36:37], v[34:35]
    v_pk_mul_f32 v[12:13], v[12:13], v[200:201]
    v_pk_mul_f32 v[14:15], v[14:15], v[202:203]
    v_pk_mul_f32 v[16:17], v[16:17], v[204:205]
    v_pk_mul_f32 v[18:19], v[18:19], v[206:207]
    v_exp_f32 v12, v12
    v_exp_f32 v13, v13
    v_exp_f32 v14, v14
    v_exp_f32 v15, v15
    v_exp_f32 v16, v16
    v_exp_f32 v17, v17
    v_exp_f32 v18, v18
    v_exp_f32 v19, v19
    v_pk_mul_f32 v[232:233], v[232:233], v[200:201]
    v_pk_mul_f32 v[234:235], v[234:235], v[202:203]
    v_pk_mul_f32 v[236:237], v[236:237], v[204:205]
    v_pk_mul_f32 v[238:239], v[238:239], v[206:207]
    v_pk_fma_f32 v[12:13], v[12:13], v[38:39], v[38:39]
    v_pk_fma_f32 v[14:15], v[14:15], v[38:39], v[38:39]
    v_pk_fma_f32 v[16:17], v[16:17], v[38:39], v[38:39]
    v_pk_fma_f32 v[18:19], v[18:19], v[38:39], v[38:39]
    v_rcp_f32 v12, v12
    v_rcp_f32 v13, v13
    v_rcp_f32 v14, v14
    v_rcp_f32 v15, v15
    v_rcp_f32 v16, v16
    v_rcp_f32 v17, v17
    v_rcp_f32 v18, v18
    v_rcp_f32 v19, v19
    s_nop 0
    v_pk_mul_f32 v[232:233], v[232:233], v[12:13]
    v_pk_mul_f32 v[234:235], v[234:235], v[14:15]
    v_pk_mul_f32 v[236:237], v[236:237], v[16:17]
    v_pk_mul_f32 v[238:239], v[238:239], v[18:19]
    v_cvt_pk_bf16_f32 v84, v232, v233
    v_cvt_pk_bf16_f32 v85, v234, v235
    v_cvt_pk_bf16_f32 v86, v236, v237
    v_cvt_pk_bf16_f32 v87, v238, v239
    v_pk_mul_f32 v[12:13], v[208:209], v[208:209]
    v_pk_mul_f32 v[14:15], v[210:211], v[210:211]
    v_pk_mul_f32 v[16:17], v[212:213], v[212:213]
    v_pk_mul_f32 v[18:19], v[214:215], v[214:215]
    v_pk_fma_f32 v[12:13], v[12:13], v[36:37], v[34:35]
    v_pk_fma_f32 v[14:15], v[14:15], v[36:37], v[34:35]
    v_pk_fma_f32 v[16:17], v[16:17], v[36:37], v[34:35]
    v_pk_fma_f32 v[18:19], v[18:19], v[36:37], v[34:35]
    v_pk_mul_f32 v[12:13], v[12:13], v[208:209]
    v_pk_mul_f32 v[14:15], v[14:15], v[210:211]
    v_pk_mul_f32 v[16:17], v[16:17], v[212:213]
    v_pk_mul_f32 v[18:19], v[18:19], v[214:215]
    v_exp_f32 v12, v12
    v_exp_f32 v13, v13
    v_exp_f32 v14, v14
    v_exp_f32 v15, v15
    v_exp_f32 v16, v16
    v_exp_f32 v17, v17
    v_exp_f32 v18, v18
    v_exp_f32 v19, v19
    v_pk_mul_f32 v[240:241], v[240:241], v[208:209]
    v_pk_mul_f32 v[242:243], v[242:243], v[210:211]
    v_pk_mul_f32 v[244:245], v[244:245], v[212:213]
    v_pk_mul_f32 v[246:247], v[246:247], v[214:215]
    v_pk_fma_f32 v[12:13], v[12:13], v[38:39], v[38:39]
    v_pk_fma_f32 v[14:15], v[14:15], v[38:39], v[38:39]
    v_pk_fma_f32 v[16:17], v[16:17], v[38:39], v[38:39]
    v_pk_fma_f32 v[18:19], v[18:19], v[38:39], v[38:39]
    v_rcp_f32 v12, v12
    v_rcp_f32 v13, v13
    v_rcp_f32 v14, v14
    v_rcp_f32 v15, v15
    v_rcp_f32 v16, v16
    v_rcp_f32 v17, v17
    v_rcp_f32 v18, v18
    v_rcp_f32 v19, v19
    s_nop 0
    v_pk_mul_f32 v[240:241], v[240:241], v[12:13]
    v_pk_mul_f32 v[242:243], v[242:243], v[14:15]
    v_pk_mul_f32 v[244:245], v[244:245], v[16:17]
    v_pk_mul_f32 v[246:247], v[246:247], v[18:19]
    v_cvt_pk_bf16_f32 v88, v240, v241
    v_cvt_pk_bf16_f32 v89, v242, v243
    v_cvt_pk_bf16_f32 v90, v244, v245
    v_cvt_pk_bf16_f32 v91, v246, v247
    v_pk_mul_f32 v[12:13], v[216:217], v[216:217]
    v_pk_mul_f32 v[14:15], v[218:219], v[218:219]
    v_pk_mul_f32 v[16:17], v[220:221], v[220:221]
    v_pk_mul_f32 v[18:19], v[222:223], v[222:223]
    v_pk_fma_f32 v[12:13], v[12:13], v[36:37], v[34:35]
    v_pk_fma_f32 v[14:15], v[14:15], v[36:37], v[34:35]
    v_pk_fma_f32 v[16:17], v[16:17], v[36:37], v[34:35]
    v_pk_fma_f32 v[18:19], v[18:19], v[36:37], v[34:35]
    v_pk_mul_f32 v[12:13], v[12:13], v[216:217]
    v_pk_mul_f32 v[14:15], v[14:15], v[218:219]
    v_pk_mul_f32 v[16:17], v[16:17], v[220:221]
    v_pk_mul_f32 v[18:19], v[18:19], v[222:223]
    v_exp_f32 v12, v12
    v_exp_f32 v13, v13
    v_exp_f32 v14, v14
    v_exp_f32 v15, v15
    v_exp_f32 v16, v16
    v_exp_f32 v17, v17
    v_exp_f32 v18, v18
    v_exp_f32 v19, v19
    v_pk_mul_f32 v[248:249], v[248:249], v[216:217]
    v_pk_mul_f32 v[250:251], v[250:251], v[218:219]
    v_pk_mul_f32 v[252:253], v[252:253], v[220:221]
    v_pk_mul_f32 v[254:255], v[254:255], v[222:223]
    v_pk_fma_f32 v[12:13], v[12:13], v[38:39], v[38:39]
    v_pk_fma_f32 v[14:15], v[14:15], v[38:39], v[38:39]
    v_pk_fma_f32 v[16:17], v[16:17], v[38:39], v[38:39]
    v_pk_fma_f32 v[18:19], v[18:19], v[38:39], v[38:39]
    v_rcp_f32 v12, v12
    v_rcp_f32 v13, v13
    v_rcp_f32 v14, v14
    v_rcp_f32 v15, v15
    v_rcp_f32 v16, v16
    v_rcp_f32 v17, v17
    v_rcp_f32 v18, v18
    v_rcp_f32 v19, v19
    s_nop 0
    v_pk_mul_f32 v[248:249], v[248:249], v[12:13]
    v_pk_mul_f32 v[250:251], v[250:251], v[14:15]
    v_pk_mul_f32 v[252:253], v[252:253], v[16:17]
    v_pk_mul_f32 v[254:255], v[254:255], v[18:19]
    v_cvt_pk_bf16_f32 v92, v248, v249
    v_cvt_pk_bf16_f32 v93, v250, v251
    v_cvt_pk_bf16_f32 v94, v252, v253
    v_cvt_pk_bf16_f32 v95, v254, v255
    s_setprio 0
    v_mov_b32 v20, 155688
    s_mov_b32 s45, 0x100000
P1_hw:
    ds_read_b32 v21, v20
    s_waitcnt lgkmcnt(0)
    v_readfirstlane_b32 s42, v21
    s_sub_u32 s45, s45, 1
    s_cselect_b32 s42, 4, s42
    s_cmp_ge_u32 s42, 4
    s_cbranch_scc1 P1_hw_ok
    s_sleep 2
    s_branch P1_hw
P1_hw_ok:
    buffer_store_dwordx4 v[64:67], v2, s[28:31], s43 offen offset:0 sc1
    buffer_store_dwordx4 v[68:71], v2, s[28:31], s43 offen offset:1024 sc1
    buffer_store_dwordx4 v[72:75], v2, s[28:31], s43 offen offset:2048 sc1
    buffer_store_dwordx4 v[76:79], v2, s[28:31], s43 offen offset:3072 sc1
    buffer_store_dwordx4 v[80:83], v2, s[28:31], s44 offen offset:0 sc1
    buffer_store_dwordx4 v[84:87], v2, s[28:31], s44 offen offset:1024 sc1
    buffer_store_dwordx4 v[88:91], v2, s[28:31], s44 offen offset:2048 sc1
    buffer_store_dwordx4 v[92:95], v2, s[28:31], s44 offen offset:3072 sc1
    v_mov_b32 v15, 0
    s_lshl_b32 s45, s33, 11
    s_lshl_b32 s42, s34, 7
    s_add_u32 s45, s45, s42
    s_add_u32 s45, s45, 17858560
    v_mov_b32 v4, 155652
    v_mov_b32 v5, 1
    s_mov_b64 exec, 1
    s_waitcnt vmcnt(0)
    ds_add_rtn_u32 v6, v4, v5
    s_waitcnt lgkmcnt(0)
    v_readfirstlane_b32 s42, v6
    s_cmp_lg_u32 s42, 3
    s_cbranch_scc1 F_sh_ns
    buffer_store_dword v5, v15, s[28:31], s45 offen sc1
F_sh_ns:
    s_mov_b64 exec, -1
F_g2:
    s_setprio 0
    s_and_b32 s47, s2, 7
    s_lshl_b32 s47, s47, 2
    s_bfe_u32 s42, s2, 0x20003
    s_add_u32 s47, s47, s42
    s_lshr_b32 s48, s2, 5
    s_lshr_b32 s15, s32, 1
    s_cmp_ge_u32 s48, 7
    s_cbranch_scc1 F_end
    s_load_dwordx2 s[24:25], s[0:1], 48
    s_load_dwordx2 s[60:61], s[0:1], 16
    s_lshl_b32 s49, s35, 14
    s_add_u32 s49, s49, 49152
    v_and_b32 v6, 15, v1
    v_lshrrev_b32 v4, 2, v6
    v_lshl_add_u32 v4, v3, 2, v4
    v_lshlrev_b32 v16, 7, v4
    v_bfe_u32 v4, v1, 4, 1
    v_lshl_add_u32 v16, v4, 5, v16
    v_and_b32 v4, 3, v6
    v_lshl_add_u32 v16, v4, 3, v16
    v_bfe_u32 v4, v6, 3, 1
    v_lshl_add_u32 v16, v4, 6, v16
    s_lshl_b32 s42, s15, 5
    v_xor_b32 v16, s42, v16
    v_xor_b32 v17, 64, v16
    v_add_u32 v18, s49, v16
    v_add_u32 v19, s49, v17
    v_bfe_u32 v4, v1, 4, 1
    v_lshlrev_b32 v4, 2, v4
    v_and_b32 v5, 7, v1
    v_xor_b32 v4, v4, v5
    v_lshrrev_b32 v6, 3, v1
    v_mul_u32_u24 v20, 896, v6
    v_lshl_add_u32 v20, v4, 4, v20
    v_add_u32 v21, 6144, v20
    v_add_u32 v22, 12288, v20
    v_add_u32 v23, 18432, v20
    v_mov_b64 v[96:97], 0
    v_mov_b64 v[98:99], 0
    s_lshl_b32 s44, s48, 7
    s_mul_i32 s40, s35, 401408
    s_add_u32 s40, s40, s44
    v_mfma_f32_32x32x16_bf16 v[128:143], v[96:99], v[96:99], 0
    v_mfma_f32_32x32x16_bf16 v[144:159], v[96:99], v[96:99], 0
    v_mfma_f32_32x32x16_bf16 v[160:175], v[96:99], v[96:99], 0
    v_mfma_f32_32x32x16_bf16 v[176:191], v[96:99], v[96:99], 0
    s_mul_i32 s54, s47, 229376
    s_mul_i32 s43, s35, 28672
    s_add_u32 s54, s54, s43
    s_add_u32 s54, s54, 6291456
    s_add_u32 s43, s54, 114688
    s_bitcmp1_b32 s32, 0
    s_cselect_b32 s55, s54, s43
    s_cselect_b32 s54, s43, s54
    s_mov_b32 s26, 1605632
    s_mov_b32 s27, 0x20000
    s_movk_i32 s14, 28672
    s_lshr_b32 s45, s47, 1
    s_lshl_b32 s45, s45, 11
    s_add_u32 s45, s45, 17858560
    v_mov_b32 v10, 155652
    s_mov_b32 s43, 0x80000
    s_branch F_bw2
F_bw2_s:
    s_sleep 2
F_bw2:
    ds_read_b32 v11, v10
    s_waitcnt lgkmcnt(0)
    v_readfirstlane_b32 s42, v11
    s_sub_u32 s43, s43, 1
    s_cselect_b32 s42, 4, s42
    s_cmp_lt_u32 s42, 4
    s_cbranch_scc1 F_bw2_s
    s_and_b32 s25, s25, 0xffff
    s_add_u32 m0, s49, 8192
    s_nop 0
    buffer_load_dwordx4 v20, s[24:27], s40 offen offset:0 lds
    buffer_load_dwordx4 v21, s[24:27], s40 offen offset:1024 lds
    buffer_load_dwordx4 v22, s[24:27], s40 offen offset:2048 lds
    buffer_load_dwordx4 v23, s[24:27], s40 offen offset:3072 lds
    s_add_u32 s40, s40, s14
    s_add_u32 m0, s49, 12288
    s_nop 0
    buffer_load_dwordx4 v20, s[24:27], s40 offen offset:0 lds
    buffer_load_dwordx4 v21, s[24:27], s40 offen offset:1024 lds
    buffer_load_dwordx4 v22, s[24:27], s40 offen offset:2048 lds
    buffer_load_dwordx4 v23, s[24:27], s40 offen offset:3072 lds
    s_add_u32 s40, s40, s14
    s_add_u32 m0, s49, 0
    s_nop 0
    buffer_load_dwordx4 v20, s[24:27], s40 offen offset:0 lds
    buffer_load_dwordx4 v21, s[24:27], s40 offen offset:1024 lds
    buffer_load_dwordx4 v22, s[24:27], s40 offen offset:2048 lds
    buffer_load_dwordx4 v23, s[24:27], s40 offen offset:3072 lds
    s_add_u32 s40, s40, s14
    s_add_u32 m0, s49, 4096
    s_nop 0
    buffer_load_dwordx4 v20, s[24:27], s40 offen offset:0 lds
    buffer_load_dwordx4 v21, s[24:27], s40 offen offset:1024 lds
    buffer_load_dwordx4 v22, s[24:27], s40 offen offset:2048 lds
    buffer_load_dwordx4 v23, s[24:27], s40 offen offset:3072 lds
    s_add_u32 s40, s40, s14
    s_mov_b32 s43, 0x8000
    v_mov_b32 v9, 155664
    s_cmp_lg_u32 s32, 4
    s_cbranch_scc1 F_ph_w
    s_mov_b64 exec, 0x3fff
    v_lshlrev_b32 v8, 7, v1
F_ph_l:
    buffer_load_dword v4, v8, s[28:31], s45 offen sc1
    s_waitcnt vmcnt(0)
    v_cmp_ne_u32 vcc, 1, v4
    s_cbranch_vccz F_ph_p
    s_sub_u32 s43, s43, 1
    s_cbranch_scc1 F_ph_p
    s_sleep 4
    s_branch F_ph_l
F_ph_p:
    v_mov_b32 v4, 1
    ds_write_b32 v9, v4
    s_mov_b64 exec, -1
    s_branch F_ph_ok
F_ph_w:
    s_lshl_b32 s43, s43, 4
F_ph_w2:
    ds_read_b32 v4, v9
    s_waitcnt lgkmcnt(0)
    v_readfirstlane_b32 s42, v4
    s_cmp_eq_u32 s42, 1
    s_cbranch_scc1 F_ph_ok
    s_sub_u32 s43, s43, 1
    s_cbranch_scc1 F_ph_ok
    s_sleep 4
    s_branch F_ph_w2
F_ph_ok:
    s_setprio 0
    buffer_load_dwordx4 v[64:67], v2, s[28:31], s54 offen sc1
    buffer_load_dwordx4 v[68:71], v2, s[28:31], s54 offen offset:1024 sc1
    buffer_load_dwordx4 v[72:75], v2, s[28:31], s55 offen sc1
    buffer_load_dwordx4 v[76:79], v2, s[28:31], s55 offen offset:1024 sc1
    s_add_u32 s54, s54, 2048
    s_add_u32 s55, s55, 2048
    buffer_load_dwordx4 v[80:83], v2, s[28:31], s54 offen sc1
    buffer_load_dwordx4 v[84:87], v2, s[28:31], s54 offen offset:1024 sc1
    buffer_load_dwordx4 v[88:91], v2, s[28:31], s55 offen sc1
    buffer_load_dwordx4 v[92:95], v2, s[28:31], s55 offen offset:1024 sc1
    s_add_u32 s54, s54, 2048
    s_add_u32 s55, s55, 2048
    buffer_load_dwordx4 v[32:35], v2, s[28:31], s54 offen sc1
    buffer_load_dwordx4 v[36:39], v2, s[28:31], s54 offen offset:1024 sc1
    buffer_load_dwordx4 v[40:43], v2, s[28:31], s55 offen sc1
    buffer_load_dwordx4 v[44:47], v2, s[28:31], s55 offen offset:1024 sc1
    s_add_u32 s54, s54, 2048
    s_add_u32 s55, s55, 2048
    buffer_load_dwordx4 v[48:51], v2, s[28:31], s54 offen sc1
    buffer_load_dwordx4 v[52:55], v2, s[28:31], s54 offen offset:1024 sc1
    buffer_load_dwordx4 v[56:59], v2, s[28:31], s55 offen sc1
    buffer_load_dwordx4 v[60:63], v2, s[28:31], s55 offen offset:1024 sc1
    s_add_u32 s54, s54, 2048
    s_add_u32 s55, s55, 2048
    s_mov_b32 s41, 4
    s_waitcnt vmcnt(4)
    s_branch F_gmid
F_gloop:
    s_cmp_lg_u32 s41, 1
    s_cbranch_scc1 F_gl2
    s_mov_b32 s24, s60
    s_and_b32 s25, s61, 0xffff
    s_mov_b32 s26, 401408
    s_movk_i32 s14, 25088
    s_mul_i32 s40, s35, 100352
    s_add_u32 s40, s40, s44
    s_mov_b32 s36, -1
    s_mov_b32 s54, 0x40000000
    s_mov_b32 s55, 0x40000000
F_gl2:
    s_waitcnt vmcnt(24)
    ds_read_b64_tr_b16 v[96:97], v18 offset:0
    ds_read_b64_tr_b16 v[98:99], v18 offset:1024
    ds_read_b64_tr_b16 v[100:101], v19 offset:0
    ds_read_b64_tr_b16 v[102:103], v19 offset:1024
    ds_read_b64_tr_b16 v[104:105], v18 offset:2048
    ds_read_b64_tr_b16 v[106:107], v18 offset:3072
    ds_read_b64_tr_b16 v[108:109], v19 offset:2048
    ds_read_b64_tr_b16 v[110:111], v19 offset:3072
    s_waitcnt lgkmcnt(4)
    v_mfma_f32_32x32x16_bf16 v[128:143], v[96:99], v[32:35], v[128:143]
    v_mfma_f32_32x32x16_bf16 v[160:175], v[96:99], v[40:43], v[160:175]
    v_mfma_f32_32x32x16_bf16 v[144:159], v[100:103], v[32:35], v[144:159]
    v_mfma_f32_32x32x16_bf16 v[176:191], v[100:103], v[40:43], v[176:191]
    s_waitcnt lgkmcnt(0)
    v_mfma_f32_32x32x16_bf16 v[128:143], v[104:107], v[36:39], v[128:143]
    v_mfma_f32_32x32x16_bf16 v[160:175], v[104:107], v[44:47], v[160:175]
    v_mfma_f32_32x32x16_bf16 v[144:159], v[108:111], v[36:39], v[144:159]
    v_mfma_f32_32x32x16_bf16 v[176:191], v[108:111], v[44:47], v[176:191]
    buffer_load_dwordx4 v[32:35], v2, s[28:31], s54 offen sc1
    buffer_load_dwordx4 v[36:39], v2, s[28:31], s54 offen offset:1024 sc1
    buffer_load_dwordx4 v[40:43], v2, s[28:31], s55 offen sc1
    buffer_load_dwordx4 v[44:47], v2, s[28:31], s55 offen offset:1024 sc1
    s_add_u32 s54, s54, 2048
    s_add_u32 s55, s55, 2048
    s_add_u32 m0, s49, 0
    s_nop 0
    buffer_load_dwordx4 v20, s[24:27], s40 offen offset:0 lds
    buffer_load_dwordx4 v21, s[24:27], s40 offen offset:1024 lds
    buffer_load_dwordx4 v22, s[24:27], s40 offen offset:2048 lds
    buffer_load_dwordx4 v23, s[24:27], s40 offen offset:3072 lds
    s_add_u32 s40, s40, s14
    s_waitcnt vmcnt(24)
    ds_read_b64_tr_b16 v[96:97], v18 offset:4096
    ds_read_b64_tr_b16 v[98:99], v18 offset:5120
    ds_read_b64_tr_b16 v[100:101], v19 offset:4096
    ds_read_b64_tr_b16 v[102:103], v19 offset:5120
    ds_read_b64_tr_b16 v[104:105], v18 offset:6144
    ds_read_b64_tr_b16 v[106:107], v18 offset:7168
    ds_read_b64_tr_b16 v[108:109], v19 offset:6144
    ds_read_b64_tr_b16 v[110:111], v19 offset:7168
    s_waitcnt lgkmcnt(4)
    v_mfma_f32_32x32x16_bf16 v[128:143], v[96:99], v[48:51], v[128:143]
    v_mfma_f32_32x32x16_bf16 v[160:175], v[96:99], v[56:59], v[160:175]
    v_mfma_f32_32x32x16_bf16 v[144:159], v[100:103], v[48:51], v[144:159]
    v_mfma_f32_32x32x16_bf16 v[176:191], v[100:103], v[56:59], v[176:191]
    s_waitcnt lgkmcnt(0)
    v_mfma_f32_32x32x16_bf16 v[128:143], v[104:107], v[52:55], v[128:143]
    v_mfma_f32_32x32x16_bf16 v[160:175], v[104:107], v[60:63], v[160:175]
    v_mfma_f32_32x32x16_bf16 v[144:159], v[108:111], v[52:55], v[144:159]
    v_mfma_f32_32x32x16_bf16 v[176:191], v[108:111], v[60:63], v[176:191]
    buffer_load_dwordx4 v[48:51], v2, s[28:31], s54 offen sc1
    buffer_load_dwordx4 v[52:55], v2, s[28:31], s54 offen offset:1024 sc1
    buffer_load_dwordx4 v[56:59], v2, s[28:31], s55 offen sc1
    buffer_load_dwordx4 v[60:63], v2, s[28:31], s55 offen offset:1024 sc1
    s_add_u32 s54, s54, 2048
    s_add_u32 s55, s55, 2048
    s_add_u32 m0, s49, 4096
    s_nop 0
    buffer_load_dwordx4 v20, s[24:27], s40 offen offset:0 lds
    buffer_load_dwordx4 v21, s[24:27], s40 offen offset:1024 lds
    buffer_load_dwordx4 v22, s[24:27], s40 offen offset:2048 lds
    buffer_load_dwordx4 v23, s[24:27], s40 offen offset:3072 lds
    s_add_u32 s40, s40, s14
F_gmid:
    s_waitcnt vmcnt(24)
    ds_read_b64_tr_b16 v[96:97], v18 offset:8192
    ds_read_b64_tr_b16 v[98:99], v18 offset:9216
    ds_read_b64_tr_b16 v[100:101], v19 offset:8192
    ds_read_b64_tr_b16 v[102:103], v19 offset:9216
    ds_read_b64_tr_b16 v[104:105], v18 offset:10240
    ds_read_b64_tr_b16 v[106:107], v18 offset:11264
    ds_read_b64_tr_b16 v[108:109], v19 offset:10240
    ds_read_b64_tr_b16 v[110:111], v19 offset:11264
    s_waitcnt lgkmcnt(4)
    v_mfma_f32_32x32x16_bf16 v[128:143], v[96:99], v[64:67], v[128:143]
    v_mfma_f32_32x32x16_bf16 v[160:175], v[96:99], v[72:75], v[160:175]
    v_mfma_f32_32x32x16_bf16 v[144:159], v[100:103], v[64:67], v[144:159]
    v_mfma_f32_32x32x16_bf16 v[176:191], v[100:103], v[72:75], v[176:191]
    s_waitcnt lgkmcnt(0)
    v_mfma_f32_32x32x16_bf16 v[128:143], v[104:107], v[68:71], v[128:143]
    v_mfma_f32_32x32x16_bf16 v[160:175], v[104:107], v[76:79], v[160:175]
    v_mfma_f32_32x32x16_bf16 v[144:159], v[108:111], v[68:71], v[144:159]
    v_mfma_f32_32x32x16_bf16 v[176:191], v[108:111], v[76:79], v[176:191]
    buffer_load_dwordx4 v[64:67], v2, s[28:31], s54 offen sc1
    buffer_load_dwordx4 v[68:71], v2, s[28:31], s54 offen offset:1024 sc1
    buffer_load_dwordx4 v[72:75], v2, s[28:31], s55 offen sc1
    buffer_load_dwordx4 v[76:79], v2, s[28:31], s55 offen offset:1024 sc1
    s_add_u32 s54, s54, 2048
    s_add_u32 s55, s55, 2048
    s_add_u32 m0, s49, 8192
    s_nop 0
    buffer_load_dwordx4 v20, s[24:27], s40 offen offset:0 lds
    buffer_load_dwordx4 v21, s[24:27], s40 offen offset:1024 lds
    buffer_load_dwordx4 v22, s[24:27], s40 offen offset:2048 lds
    buffer_load_dwordx4 v23, s[24:27], s40 offen offset:3072 lds
    s_add_u32 s40, s40, s14
    s_waitcnt vmcnt(24)
    ds_read_b64_tr_b16 v[96:97], v18 offset:12288
    ds_read_b64_tr_b16 v[98:99], v18 offset:13312
    ds_read_b64_tr_b16 v[100:101], v19 offset:12288
    ds_read_b64_tr_b16 v[102:103], v19 offset:13312
    ds_read_b64_tr_b16 v[104:105], v18 offset:14336
    ds_read_b64_tr_b16 v[106:107], v18 offset:15360
    ds_read_b64_tr_b16 v[108:109], v19 offset:14336
    ds_read_b64_tr_b16 v[110:111], v19 offset:15360
    s_waitcnt lgkmcnt(4)
    v_mfma_f32_32x32x16_bf16 v[128:143], v[96:99], v[80:83], v[128:143]
    v_mfma_f32_32x32x16_bf16 v[160:175], v[96:99], v[88:91], v[160:175]
    v_mfma_f32_32x32x16_bf16 v[144:159], v[100:103], v[80:83], v[144:159]
    v_mfma_f32_32x32x16_bf16 v[176:191], v[100:103], v[88:91], v[176:191]
    s_waitcnt lgkmcnt(0)
    v_mfma_f32_32x32x16_bf16 v[128:143], v[104:107], v[84:87], v[128:143]
    v_mfma_f32_32x32x16_bf16 v[160:175], v[104:107], v[92:95], v[160:175]
    v_mfma_f32_32x32x16_bf16 v[144:159], v[108:111], v[84:87], v[144:159]
    v_mfma_f32_32x32x16_bf16 v[176:191], v[108:111], v[92:95], v[176:191]
    buffer_load_dwordx4 v[80:83], v2, s[28:31], s54 offen sc1
    buffer_load_dwordx4 v[84:87], v2, s[28:31], s54 offen offset:1024 sc1
    buffer_load_dwordx4 v[88:91], v2, s[28:31], s55 offen sc1
    buffer_load_dwordx4 v[92:95], v2, s[28:31], s55 offen offset:1024 sc1
    s_add_u32 s54, s54, 2048
    s_add_u32 s55, s55, 2048
    s_add_u32 m0, s49, 12288
    s_nop 0
    buffer_load_dwordx4 v20, s[24:27], s40 offen offset:0 lds
    buffer_load_dwordx4 v21, s[24:27], s40 offen offset:1024 lds
    buffer_load_dwordx4 v22, s[24:27], s40 offen offset:2048 lds
    buffer_load_dwordx4 v23, s[24:27], s40 offen offset:3072 lds
    s_add_u32 s40, s40, s14
    s_sub_u32 s41, s41, 1
    s_cmp_lg_u32 s41, 0
    s_cbranch_scc1 F_gloop
    s_setprio 0
    s_xor_b32 s42, s35, 1
    s_lshl_b32 s42, s42, 13
    s_add_u32 s42, s42, 114688
    v_add_u32 v4, s42, v2
    v_xor_b32 v5, 0x2000, v4
    ds_write_b128 v4, v[160:163] offset:0
    ds_write_b128 v4, v[164:167] offset:1024
    ds_write_b128 v4, v[168:171] offset:2048
    ds_write_b128 v4, v[172:175] offset:3072
    ds_write_b128 v4, v[176:179] offset:4096
    ds_write_b128 v4, v[180:183] offset:5120
    ds_write_b128 v4, v[184:187] offset:6144
    ds_write_b128 v4, v[188:191] offset:7168
    v_mov_b32 v10, 155676
    v_mov_b32 v11, 1
    s_mov_b64 exec, 1
    ds_add_u32 v10, v11
    s_mov_b64 exec, -1
    v_mov_b32 v10, 155676
    s_mov_b32 s43, 0x80000
    s_branch F_xw
F_xw_s:
    s_sleep 4
F_xw:
    ds_read_b32 v11, v10
    s_waitcnt lgkmcnt(0)
    v_readfirstlane_b32 s42, v11
    s_sub_u32 s43, s43, 1
    s_cselect_b32 s42, 4, s42
    s_cmp_lt_u32 s42, 4
    s_cbranch_scc1 F_xw_s
    ds_read_b128 v[160:163], v5 offset:0
    ds_read_b128 v[164:167], v5 offset:1024
    ds_read_b128 v[168:171], v5 offset:2048
    ds_read_b128 v[172:175], v5 offset:3072
    ds_read_b128 v[176:179], v5 offset:4096
    ds_read_b128 v[180:183], v5 offset:5120
    ds_read_b128 v[184:187], v5 offset:6144
    ds_read_b128 v[188:191], v5 offset:7168
    s_waitcnt vmcnt(0) lgkmcnt(0)
    v_mov_b32 v10, 155680
    v_mov_b32 v11, 1
    s_mov_b64 exec, 1
    ds_add_u32 v10, v11
    s_mov_b64 exec, -1
    v_pk_add_f32 v[128:129], v[128:129], v[160:161]
    v_pk_add_f32 v[130:131], v[130:131], v[162:163]
    v_pk_add_f32 v[132:133], v[132:133], v[164:165]
    v_pk_add_f32 v[134:135], v[134:135], v[166:167]
    v_pk_add_f32 v[136:137], v[136:137], v[168:169]
    v_pk_add_f32 v[138:139], v[138:139], v[170:171]
    v_pk_add_f32 v[140:141], v[140:141], v[172:173]
    v_pk_add_f32 v[142:143], v[142:143], v[174:175]
    v_pk_add_f32 v[144:145], v[144:145], v[176:177]
    v_pk_add_f32 v[146:147], v[146:147], v[178:179]
    v_pk_add_f32 v[148:149], v[148:149], v[180:181]
    v_pk_add_f32 v[150:151], v[150:151], v[182:183]
    v_pk_add_f32 v[152:153], v[152:153], v[184:185]
    v_pk_add_f32 v[154:155], v[154:155], v[186:187]
    v_pk_add_f32 v[156:157], v[156:157], v[188:189]
    v_pk_add_f32 v[158:159], v[158:159], v[190:191]
F_tail:
    s_load_dwordx2 s[60:61], s[0:1], 0
    s_load_dwordx2 s[24:25], s[0:1], 56
    s_lshr_b32 s45, s47, 1
    s_lshl_b32 s45, s45, 11
    s_add_u32 s45, s45, 17891328
    s_and_b32 s44, s32, 1
    s_lshl_b32 s42, s47, 1
    s_add_u32 s44, s44, s42
    s_lshl_b32 s54, s44, 15
    s_lshl_b32 s42, s15, 13
    s_add_u32 s54, s54, s42
    s_add_u32 s54, s54, 14680064
    s_add_u32 s55, s54, 4096
    s_mul_i32 s44, s44, 28672
    s_lshl_b32 s42, s48, 7
    s_add_u32 s44, s44, s42
    s_lshl_b32 s42, s15, 5
    s_add_u32 s44, s44, s42
    v_and_b32 v28, 31, v1
    v_mul_u32_u24 v28, 896, v28
    v_lshl_add_u32 v29, v3, 3, v28
    v_lshl_add_u32 v28, v3, 4, v28
    s_lshl_b32 s42, s15, 14
    s_add_u32 s42, s42, 49152
    v_add_u32 v16, s42, v16
    v_add_u32 v17, s42, v17
    s_mov_b32 s62, 1835008
    s_mov_b32 s63, 0x20000
    s_mov_b32 s26, 1835008
    s_mov_b32 s27, 0x20000
    v_mov_b32 v10, 155680
    s_mov_b32 s43, 0x80000
    s_branch F_ww
F_ww_s:
    s_sleep 2
F_ww:
    ds_read_b32 v11, v10
    s_waitcnt lgkmcnt(0)
    v_readfirstlane_b32 s42, v11
    s_sub_u32 s43, s43, 1
    s_cselect_b32 s42, 4, s42
    s_cmp_lt_u32 s42, 4
    s_cbranch_scc1 F_ww_s
    s_and_b32 s61, s61, 0xffff
    s_and_b32 s25, s25, 0xffff
    buffer_load_dwordx2 v[24:25], v29, s[60:63], s44 offen
    buffer_load_dwordx2 v[26:27], v29, s[60:63], s44 offen offset:16
    ds_read_b64_tr_b16 v[192:193], v16 offset:0
    ds_read_b64_tr_b16 v[194:195], v16 offset:1024
    ds_read_b64_tr_b16 v[196:197], v17 offset:0
    ds_read_b64_tr_b16 v[198:199], v17 offset:1024
    ds_read_b64_tr_b16 v[200:201], v16 offset:2048
    ds_read_b64_tr_b16 v[202:203], v16 offset:3072
    ds_read_b64_tr_b16 v[204:205], v17 offset:2048
    ds_read_b64_tr_b16 v[206:207], v17 offset:3072
    ds_read_b64_tr_b16 v[208:209], v16 offset:4096
    ds_read_b64_tr_b16 v[210:211], v16 offset:5120
    ds_read_b64_tr_b16 v[212:213], v17 offset:4096
    ds_read_b64_tr_b16 v[214:215], v17 offset:5120
    ds_read_b64_tr_b16 v[216:217], v16 offset:6144
    ds_read_b64_tr_b16 v[218:219], v16 offset:7168
    ds_read_b64_tr_b16 v[220:221], v17 offset:6144
    ds_read_b64_tr_b16 v[222:223], v17 offset:7168
    ds_read_b64_tr_b16 v[224:225], v16 offset:8192
    ds_read_b64_tr_b16 v[226:227], v16 offset:9216
    ds_read_b64_tr_b16 v[228:229], v17 offset:8192
    ds_read_b64_tr_b16 v[230:231], v17 offset:9216
    ds_read_b64_tr_b16 v[232:233], v16 offset:10240
    ds_read_b64_tr_b16 v[234:235], v16 offset:11264
    ds_read_b64_tr_b16 v[236:237], v17 offset:10240
    ds_read_b64_tr_b16 v[238:239], v17 offset:11264
    ds_read_b64_tr_b16 v[240:241], v16 offset:12288
    ds_read_b64_tr_b16 v[242:243], v16 offset:13312
    ds_read_b64_tr_b16 v[244:245], v17 offset:12288
    ds_read_b64_tr_b16 v[246:247], v17 offset:13312
    ds_read_b64_tr_b16 v[248:249], v16 offset:14336
    ds_read_b64_tr_b16 v[250:251], v16 offset:15360
    ds_read_b64_tr_b16 v[252:253], v17 offset:14336
    ds_read_b64_tr_b16 v[254:255], v17 offset:15360
    s_xor_b32 s42, s32, 2
    s_mul_i32 s42, s42, 6144
    v_add_u32 v21, s42, v2
    s_xor_b32 s42, s32, 4
    s_mul_i32 s42, s42, 6144
    v_add_u32 v22, s42, v2
    s_xor_b32 s42, s32, 6
    s_mul_i32 s42, s42, 6144
    v_add_u32 v23, s42, v2
    s_mul_i32 s42, s32, 6144
    v_add_u32 v20, s42, v2
    v_mov_b32 v10, 155656
    s_mov_b32 s43, 0x80000
    s_branch F_ow
F_ow_s:
    s_sleep 4
F_ow:
    ds_read_b32 v11, v10
    s_waitcnt lgkmcnt(0)
    v_readfirstlane_b32 s42, v11
    s_sub_u32 s43, s43, 1
    s_cselect_b32 s42, 4, s42
    s_cmp_lt_u32 s42, 4
    s_cbranch_scc1 F_ow_s
    s_lshl_b32 s42, s15, 9
    s_add_u32 s45, s45, s42
    s_and_b32 s42, s47, 1
    s_lshl_b32 s42, s42, 3
    s_add_u32 s45, s45, s42
    s_and_b32 s42, s32, 1
    s_lshl_b32 s42, s42, 2
    s_add_u32 s45, s45, s42
    v_lshlrev_b32 v8, 7, v1
    s_mov_b32 s43, 0x8000
    s_mov_b64 exec, 0xf
F_po_l:
    buffer_load_dword v4, v8, s[28:31], s45 offen sc1
    s_waitcnt vmcnt(0)
    v_cmp_ne_u32 vcc, 1, v4
    s_cbranch_vccz F_po_ok
    s_sub_u32 s43, s43, 1
    s_cbranch_scc1 F_po_ok
    s_sleep 2
    s_branch F_po_l
F_po_ok:
    s_mov_b64 exec, -1
    buffer_load_dwordx4 v[32:35], v2, s[28:31], s54 offen offset:0 sc1
    buffer_load_dwordx4 v[36:39], v2, s[28:31], s54 offen offset:1024 sc1
    buffer_load_dwordx4 v[40:43], v2, s[28:31], s54 offen offset:2048 sc1
    buffer_load_dwordx4 v[44:47], v2, s[28:31], s54 offen offset:3072 sc1
    buffer_load_dwordx4 v[48:51], v2, s[28:31], s55 offen offset:0 sc1
    buffer_load_dwordx4 v[52:55], v2, s[28:31], s55 offen offset:1024 sc1
    buffer_load_dwordx4 v[56:59], v2, s[28:31], s55 offen offset:2048 sc1
    buffer_load_dwordx4 v[60:63], v2, s[28:31], s55 offen offset:3072 sc1
    s_waitcnt vmcnt(8)
    v_lshlrev_b32 v64, 16, v24
    v_and_b32 v65, s46, v24
    v_lshlrev_b32 v66, 16, v25
    v_and_b32 v67, s46, v25
    v_lshlrev_b32 v68, 16, v26
    v_and_b32 v69, s46, v26
    v_lshlrev_b32 v70, 16, v27
    v_and_b32 v71, s46, v27
    s_waitcnt vmcnt(7)
    v_mfma_f32_32x32x16_bf16 v[128:143], v[192:195], v[32:35], v[128:143]
    v_mfma_f32_32x32x16_bf16 v[144:159], v[196:199], v[32:35], v[144:159]
    s_waitcnt vmcnt(6)
    v_mfma_f32_32x32x16_bf16 v[128:143], v[200:203], v[36:39], v[128:143]
    v_mfma_f32_32x32x16_bf16 v[144:159], v[204:207], v[36:39], v[144:159]
    s_waitcnt vmcnt(5)
    v_mfma_f32_32x32x16_bf16 v[128:143], v[208:211], v[40:43], v[128:143]
    v_mfma_f32_32x32x16_bf16 v[144:159], v[212:215], v[40:43], v[144:159]
    s_waitcnt vmcnt(4)
    v_mfma_f32_32x32x16_bf16 v[128:143], v[216:219], v[44:47], v[128:143]
    v_mfma_f32_32x32x16_bf16 v[144:159], v[220:223], v[44:47], v[144:159]
    s_waitcnt vmcnt(3)
    v_mfma_f32_32x32x16_bf16 v[128:143], v[224:227], v[48:51], v[128:143]
    v_mfma_f32_32x32x16_bf16 v[144:159], v[228:231], v[48:51], v[144:159]
    s_waitcnt vmcnt(2)
    v_mfma_f32_32x32x16_bf16 v[128:143], v[232:235], v[52:55], v[128:143]
    v_mfma_f32_32x32x16_bf16 v[144:159], v[236:239], v[52:55], v[144:159]
    s_waitcnt vmcnt(1)
    v_mfma_f32_32x32x16_bf16 v[128:143], v[240:243], v[56:59], v[128:143]
    v_mfma_f32_32x32x16_bf16 v[144:159], v[244:247], v[56:59], v[144:159]
    s_waitcnt vmcnt(0)
    v_mfma_f32_32x32x16_bf16 v[128:143], v[248:251], v[60:63], v[128:143]
    v_mfma_f32_32x32x16_bf16 v[144:159], v[252:255], v[60:63], v[144:159]
    s_nop 10
    ds_write_b128 v21, v[136:139] offset:0
    ds_write_b128 v21, v[140:143] offset:1024
    ds_write_b128 v22, v[144:147] offset:2048
    ds_write_b128 v22, v[148:151] offset:3072
    ds_write_b128 v23, v[152:155] offset:4096
    ds_write_b128 v23, v[156:159] offset:5120
    v_add_f32 v64, v64, v128
    v_add_f32 v65, v65, v129
    v_add_f32 v66, v66, v130
    v_add_f32 v67, v67, v131
    v_add_f32 v68, v68, v132
    v_add_f32 v69, v69, v133
    v_add_f32 v70, v70, v134
    v_add_f32 v71, v71, v135
    s_waitcnt lgkmcnt(0)
    s_barrier
    ds_read_b128 v[160:163], v20 offset:0
    ds_read_b128 v[164:167], v20 offset:1024
    ds_read_b128 v[168:171], v20 offset:2048
    ds_read_b128 v[172:175], v20 offset:3072
    ds_read_b128 v[176:179], v20 offset:4096
    ds_read_b128 v[180:183], v20 offset:5120
    s_waitcnt lgkmcnt(4)
    v_add_f32 v64, v64, v160
    v_add_f32 v65, v65, v161
    v_add_f32 v66, v66, v162
    v_add_f32 v67, v67, v163
    v_add_f32 v68, v68, v164
    v_add_f32 v69, v69, v165
    v_add_f32 v70, v70, v166
    v_add_f32 v71, v71, v167
    s_waitcnt lgkmcnt(2)
    v_add_f32 v64, v64, v168
    v_add_f32 v65, v65, v169
    v_add_f32 v66, v66, v170
    v_add_f32 v67, v67, v171
    v_add_f32 v68, v68, v172
    v_add_f32 v69, v69, v173
    v_add_f32 v70, v70, v174
    v_add_f32 v71, v71, v175
    s_waitcnt lgkmcnt(0)
    v_add_f32 v64, v64, v176
    v_add_f32 v65, v65, v177
    v_add_f32 v66, v66, v178
    v_add_f32 v67, v67, v179
    v_add_f32 v68, v68, v180
    v_add_f32 v69, v69, v181
    v_add_f32 v70, v70, v182
    v_add_f32 v71, v71, v183
    v_cvt_pk_bf16_f32 v24, v64, v65
    v_cvt_pk_bf16_f32 v25, v66, v67
    v_cvt_pk_bf16_f32 v26, v68, v69
    v_cvt_pk_bf16_f32 v27, v70, v71
    s_nop 1
    v_permlane32_swap_b32 v24, v26
    v_permlane32_swap_b32 v25, v27
    buffer_store_dwordx4 v[24:27], v28, s[24:27], s44 offen
F_end:
    s_endpgm
P1_help:
    s_lshl_b32 s41, s33, 1
    s_add_u32 s41, s41, s34
    s_sub_u32 s41, s41, 14
    v_mov_b64 v[92:93], -1
    v_mov_b64 v[94:95], -1
    s_lshl_b32 s42, s32, 5
    s_add_u32 s42, s42, s41
    s_cmp_lt_u32 s42, 77
    s_cselect_b32 s43, 16842752, -1
    s_cselect_b32 s42, s42, 0
    s_lshl_b32 s42, s42, 10
    s_add_u32 s38, s42, s43
    s_cmp_lg_u32 s32, 0
    s_cbranch_scc1 P1_hc
    buffer_store_dwordx4 v[92:95], v2, s[28:31], s38 offen sc1
    s_add_u32 s42, s38, 32768
    buffer_store_dwordx4 v[92:95], v2, s[28:31], s42 offen sc1
    s_add_u32 s42, s38, 65536
    buffer_store_dwordx4 v[92:95], v2, s[28:31], s42 offen sc1
    s_lshl_b32 s42, s41, 10
    s_add_u32 s42, s42, 16777216
    buffer_store_dwordx4 v[92:95], v2, s[28:31], s42 offen sc1
    s_lshl_b32 s42, s41, 8
    s_add_u32 s42, s42, 16809984
    s_mov_b64 exec, 0xffff
    buffer_store_dwordx4 v[92:95], v2, s[28:31], s42 offen sc1
    s_mul_i32 s42, s41, 3072
    s_add_u32 s42, s42, 17825792
    s_mov_b64 exec, s[50:51]
    v_lshrrev_b32 v60, 1, v1
    v_mul_u32_u24 v60, 96, v60
    v_add_u32 v60, v60, v2
    buffer_store_dwordx4 v[20:23], v60, s[28:31], s42 offen sc1
    v_mov_b32 v61, 1
    s_mov_b64 exec, 1
    s_waitcnt vmcnt(0)
    buffer_atomic_add v61, v54, s[56:59], 0 offen sc0 sc1
    s_waitcnt vmcnt(0)
    v_readfirstlane_b32 s42, v61
    v_mov_b32 v61, 1
    s_cmp_lg_u32 s42, 31
    s_cbranch_scc1 P1_hg
    buffer_store_dword v61, v54, s[56:59], 0 offen offset:128 sc1
P1_hg:
    s_mov_b64 exec, -1
P1_hc:
    v_mul_u32_u24 v13, 896, v16
    v_lshl_add_u32 v15, v17, 4, v13
    s_lshl_b32 s48, s41, 3
    s_add_u32 s48, s48, s32
    s_mul_i32 s54, s48, 7168
    buffer_load_dwordx4 v[64:67], v15, s[16:19], s54 offen offset:0
    buffer_load_dwordx4 v[68:71], v15, s[16:19], s54 offen offset:128
    buffer_load_dwordx4 v[72:75], v15, s[16:19], s54 offen offset:256
    buffer_load_dwordx4 v[76:79], v15, s[16:19], s54 offen offset:384
    buffer_load_dwordx4 v[80:83], v15, s[16:19], s54 offen offset:512
    buffer_load_dwordx4 v[84:87], v15, s[16:19], s54 offen offset:640
    buffer_load_dwordx4 v[88:91], v15, s[16:19], s54 offen offset:768
    s_mov_b32 s27, 0x20000
    s_add_u32 s39, s41, 0
    s_cmp_lt_u32 s39, 21
    s_cselect_b32 s24, s6, s8
    s_cselect_b32 s25, s7, s9
    s_cselect_b32 s42, 0, 21
    s_movk_i32 s43, 3584
    s_cselect_b32 s43, 2688, s43
    s_and_b32 s25, s25, 0xffff
    s_mul_i32 s26, s43, 448
    v_mul_u32_u24 v51, s43, v16
    v_lshl_add_u32 v51, v17, 4, v51
    s_mul_i32 s45, s32, 56
    s_mul_i32 s45, s45, s43
    s_lshl_b32 s44, s43, 3
    s_sub_u32 s42, s39, s42
    s_lshl_b32 s42, s42, 7
    s_add_u32 s37, s45, s42
    buffer_load_dwordx4 v[128:131], v51, s[24:27], s37 offen
    s_add_u32 s37, s37, s44
    buffer_load_dwordx4 v[132:135], v51, s[24:27], s37 offen
    s_add_u32 s37, s37, s44
    buffer_load_dwordx4 v[136:139], v51, s[24:27], s37 offen
    s_add_u32 s37, s37, s44
    buffer_load_dwordx4 v[140:143], v51, s[24:27], s37 offen
    s_add_u32 s37, s37, s44
    buffer_load_dwordx4 v[144:147], v51, s[24:27], s37 offen
    s_add_u32 s37, s37, s44
    buffer_load_dwordx4 v[148:151], v51, s[24:27], s37 offen
    s_add_u32 s37, s37, s44
    buffer_load_dwordx4 v[152:155], v51, s[24:27], s37 offen
    v_mov_b32 v14, 0x3f803f80
    v_mov_b32 v43, 1.0
    v_mov_b64 v[40:41], 0
    v_mov_b32 v42, 0x00003f80
    s_waitcnt vmcnt(7)
    v_dot2c_f32_bf16 v40, v64, v14
    v_dot2c_f32_bf16 v41, v65, v14
    v_dot2c_f32_bf16 v40, v66, v14
    v_dot2c_f32_bf16 v41, v67, v14
    v_dot2c_f32_bf16 v40, v68, v14
    v_dot2c_f32_bf16 v41, v69, v14
    v_dot2c_f32_bf16 v40, v70, v14
    v_dot2c_f32_bf16 v41, v71, v14
    v_dot2c_f32_bf16 v40, v72, v14
    v_dot2c_f32_bf16 v41, v73, v14
    v_dot2c_f32_bf16 v40, v74, v14
    v_dot2c_f32_bf16 v41, v75, v14
    v_dot2c_f32_bf16 v40, v76, v14
    v_dot2c_f32_bf16 v41, v77, v14
    v_dot2c_f32_bf16 v40, v78, v14
    v_dot2c_f32_bf16 v41, v79, v14
    v_dot2c_f32_bf16 v40, v80, v14
    v_dot2c_f32_bf16 v41, v81, v14
    v_dot2c_f32_bf16 v40, v82, v14
    v_dot2c_f32_bf16 v41, v83, v14
    v_dot2c_f32_bf16 v40, v84, v14
    v_dot2c_f32_bf16 v41, v85, v14
    v_dot2c_f32_bf16 v40, v86, v14
    v_dot2c_f32_bf16 v41, v87, v14
    v_dot2c_f32_bf16 v40, v88, v14
    v_dot2c_f32_bf16 v41, v89, v14
    v_dot2c_f32_bf16 v40, v90, v14
    v_dot2c_f32_bf16 v41, v91, v14
    s_nop 2
    v_add_f32 v46, v40, v41
    s_nop 1
    v_add_f32_dpp v46, v46, v46 quad_perm:[1,0,3,2] row_mask:0xf bank_mask:0xf
    s_nop 1
    v_add_f32_dpp v46, v46, v46 quad_perm:[2,3,0,1] row_mask:0xf bank_mask:0xf
    s_nop 1
    v_add_f32_dpp v46, v46, v46 row_half_mirror row_mask:0xf bank_mask:0xf
    v_mul_f32 v46, 0xbb124925, v46
    v_mov_b64 v[40:41], 0
    v_dot2_f32_bf16 v96, v64, v42, v46
    v_dot2_f32_bf16 v97, v64, v43, v46
    v_dot2_f32_bf16 v98, v65, v42, v46
    v_dot2_f32_bf16 v99, v65, v43, v46
    v_dot2_f32_bf16 v100, v66, v42, v46
    v_dot2_f32_bf16 v101, v66, v43, v46
    v_dot2_f32_bf16 v102, v67, v42, v46
    v_dot2_f32_bf16 v103, v67, v43, v46
    s_nop 1
    v_fmac_f32 v40, v96, v96
    v_fmac_f32 v41, v97, v97
    v_fmac_f32 v40, v98, v98
    v_fmac_f32 v41, v99, v99
    v_fmac_f32 v40, v100, v100
    v_fmac_f32 v41, v101, v101
    v_fmac_f32 v40, v102, v102
    v_fmac_f32 v41, v103, v103
    v_dot2_f32_bf16 v96, v68, v42, v46
    v_dot2_f32_bf16 v97, v68, v43, v46
    v_dot2_f32_bf16 v98, v69, v42, v46
    v_dot2_f32_bf16 v99, v69, v43, v46
    v_dot2_f32_bf16 v100, v70, v42, v46
    v_dot2_f32_bf16 v101, v70, v43, v46
    v_dot2_f32_bf16 v102, v71, v42, v46
    v_dot2_f32_bf16 v103, v71, v43, v46
    s_nop 1
    v_fmac_f32 v40, v96, v96
    v_fmac_f32 v41, v97, v97
    v_fmac_f32 v40, v98, v98
    v_fmac_f32 v41, v99, v99
    v_fmac_f32 v40, v100, v100
    v_fmac_f32 v41, v101, v101
    v_fmac_f32 v40, v102, v102
    v_fmac_f32 v41, v103, v103
    v_dot2_f32_bf16 v96, v72, v42, v46
    v_dot2_f32_bf16 v97, v72, v43, v46
    v_dot2_f32_bf16 v98, v73, v42, v46
    v_dot2_f32_bf16 v99, v73, v43, v46
    v_dot2_f32_bf16 v100, v74, v42, v46
    v_dot2_f32_bf16 v101, v74, v43, v46
    v_dot2_f32_bf16 v102, v75, v42, v46
    v_dot2_f32_bf16 v103, v75, v43, v46
    s_nop 1
    v_fmac_f32 v40, v96, v96
    v_fmac_f32 v41, v97, v97
    v_fmac_f32 v40, v98, v98
    v_fmac_f32 v41, v99, v99
    v_fmac_f32 v40, v100, v100
    v_fmac_f32 v41, v101, v101
    v_fmac_f32 v40, v102, v102
    v_fmac_f32 v41, v103, v103
    v_dot2_f32_bf16 v96, v76, v42, v46
    v_dot2_f32_bf16 v97, v76, v43, v46
    v_dot2_f32_bf16 v98, v77, v42, v46
    v_dot2_f32_bf16 v99, v77, v43, v46
    v_dot2_f32_bf16 v100, v78, v42, v46
    v_dot2_f32_bf16 v101, v78, v43, v46
    v_dot2_f32_bf16 v102, v79, v42, v46
    v_dot2_f32_bf16 v103, v79, v43, v46
    s_nop 1
    v_fmac_f32 v40, v96, v96
    v_fmac_f32 v41, v97, v97
    v_fmac_f32 v40, v98, v98
    v_fmac_f32 v41, v99, v99
    v_fmac_f32 v40, v100, v100
    v_fmac_f32 v41, v101, v101
    v_fmac_f32 v40, v102, v102
    v_fmac_f32 v41, v103, v103
    v_dot2_f32_bf16 v96, v80, v42, v46
    v_dot2_f32_bf16 v97, v80, v43, v46
    v_dot2_f32_bf16 v98, v81, v42, v46
    v_dot2_f32_bf16 v99, v81, v43, v46
    v_dot2_f32_bf16 v100, v82, v42, v46
    v_dot2_f32_bf16 v101, v82, v43, v46
    v_dot2_f32_bf16 v102, v83, v42, v46
    v_dot2_f32_bf16 v103, v83, v43, v46
    s_nop 1
    v_fmac_f32 v40, v96, v96
    v_fmac_f32 v41, v97, v97
    v_fmac_f32 v40, v98, v98
    v_fmac_f32 v41, v99, v99
    v_fmac_f32 v40, v100, v100
    v_fmac_f32 v41, v101, v101
    v_fmac_f32 v40, v102, v102
    v_fmac_f32 v41, v103, v103
    v_dot2_f32_bf16 v96, v84, v42, v46
    v_dot2_f32_bf16 v97, v84, v43, v46
    v_dot2_f32_bf16 v98, v85, v42, v46
    v_dot2_f32_bf16 v99, v85, v43, v46
    v_dot2_f32_bf16 v100, v86, v42, v46
    v_dot2_f32_bf16 v101, v86, v43, v46
    v_dot2_f32_bf16 v102, v87, v42, v46
    v_dot2_f32_bf16 v103, v87, v43, v46
    s_nop 1
    v_fmac_f32 v40, v96, v96
    v_fmac_f32 v41, v97, v97
    v_fmac_f32 v40, v98, v98
    v_fmac_f32 v41, v99, v99
    v_fmac_f32 v40, v100, v100
    v_fmac_f32 v41, v101, v101
    v_fmac_f32 v40, v102, v102
    v_fmac_f32 v41, v103, v103
    v_dot2_f32_bf16 v96, v88, v42, v46
    v_dot2_f32_bf16 v97, v88, v43, v46
    v_dot2_f32_bf16 v98, v89, v42, v46
    v_dot2_f32_bf16 v99, v89, v43, v46
    v_dot2_f32_bf16 v100, v90, v42, v46
    v_dot2_f32_bf16 v101, v90, v43, v46
    v_dot2_f32_bf16 v102, v91, v42, v46
    v_dot2_f32_bf16 v103, v91, v43, v46
    s_nop 1
    v_fmac_f32 v40, v96, v96
    v_fmac_f32 v41, v97, v97
    v_fmac_f32 v40, v98, v98
    v_fmac_f32 v41, v99, v99
    v_fmac_f32 v40, v100, v100
    v_fmac_f32 v41, v101, v101
    v_fmac_f32 v40, v102, v102
    v_fmac_f32 v41, v103, v103
    s_nop 2
    v_add_f32 v47, v40, v41
    s_nop 1
    v_add_f32_dpp v47, v47, v47 quad_perm:[1,0,3,2] row_mask:0xf bank_mask:0xf
    s_nop 1
    v_add_f32_dpp v47, v47, v47 quad_perm:[2,3,0,1] row_mask:0xf bank_mask:0xf
    s_nop 1
    v_add_f32_dpp v47, v47, v47 row_half_mirror row_mask:0xf bank_mask:0xf
    v_mov_b32 v44, 0x3727c5ac
    v_fmac_f32 v44, 0x3b124925, v47
    v_rsq_f32 v47, v44
    v_and_b32 v48, s46, v46
    v_sub_f32 v44, v46, v48
    v_and_b32 v49, s46, v44
    v_sub_f32 v44, v44, v49
    v_and_b32 v50, s46, v44
    v_lshrrev_b32 v44, 16, v48
    v_lshrrev_b32 v45, 16, v49
    v_or_b32 v56, v44, v48
    v_or_b32 v57, v45, v48
    v_or_b32 v58, v45, v50
    v_or_b32 v59, v45, v50
    v_lshlrev_b32 v44, 4, v16
    v_lshlrev_b32 v45, 2, v16
    s_lshl_b32 s54, s48, 7
    s_add_u32 s54, s54, 16777216
    s_lshl_b32 s53, s48, 5
    s_add_u32 s53, s53, 16809984
    s_barrier
    s_mov_b32 exec_lo, 0x01010101
    s_mov_b32 exec_hi, 0x01010101
    buffer_store_dwordx4 v[56:59], v44, s[28:31], s54 offen sc1
    buffer_store_dword v47, v45, s[28:31], s53 offen sc1
    s_mov_b64 exec, -1
    s_mul_i32 s42, s32, 2176
    v_mul_u32_u24 v18, 272, v16
    v_lshl_add_u32 v18, v17, 5, v18
    v_add_u32 v18, s42, v18
    v_lshl_add_u32 v19, v1, 2, s42
    v_add_u32 v13, 1088, v19
    v_lshlrev_b32 v15, 2, v0
    v_mov_b64 v[64:65], 0
    v_mov_b64 v[66:67], 0
    v_mov_b64 v[68:69], 0
    v_mov_b64 v[70:71], 0
    s_waitcnt vmcnt(2)
    v_dot2c_f32_bf16 v64, v128, v42
    v_dot2c_f32_bf16 v65, v128, v43
    v_dot2c_f32_bf16 v66, v129, v42
    v_dot2c_f32_bf16 v67, v129, v43
    v_dot2c_f32_bf16 v68, v130, v42
    v_dot2c_f32_bf16 v69, v130, v43
    v_dot2c_f32_bf16 v70, v131, v42
    v_dot2c_f32_bf16 v71, v131, v43
    v_dot2c_f32_bf16 v64, v132, v42
    v_dot2c_f32_bf16 v65, v132, v43
    v_dot2c_f32_bf16 v66, v133, v42
    v_dot2c_f32_bf16 v67, v133, v43
    v_dot2c_f32_bf16 v68, v134, v42
    v_dot2c_f32_bf16 v69, v134, v43
    v_dot2c_f32_bf16 v70, v135, v42
    v_dot2c_f32_bf16 v71, v135, v43
    v_dot2c_f32_bf16 v64, v136, v42
    v_dot2c_f32_bf16 v65, v136, v43
    v_dot2c_f32_bf16 v66, v137, v42
    v_dot2c_f32_bf16 v67, v137, v43
    v_dot2c_f32_bf16 v68, v138, v42
    v_dot2c_f32_bf16 v69, v138, v43
    v_dot2c_f32_bf16 v70, v139, v42
    v_dot2c_f32_bf16 v71, v139, v43
    v_dot2c_f32_bf16 v64, v140, v42
    v_dot2c_f32_bf16 v65, v140, v43
    v_dot2c_f32_bf16 v66, v141, v42
    v_dot2c_f32_bf16 v67, v141, v43
    v_dot2c_f32_bf16 v68, v142, v42
    v_dot2c_f32_bf16 v69, v142, v43
    v_dot2c_f32_bf16 v70, v143, v42
    v_dot2c_f32_bf16 v71, v143, v43
    v_dot2c_f32_bf16 v64, v144, v42
    v_dot2c_f32_bf16 v65, v144, v43
    v_dot2c_f32_bf16 v66, v145, v42
    v_dot2c_f32_bf16 v67, v145, v43
    v_dot2c_f32_bf16 v68, v146, v42
    v_dot2c_f32_bf16 v69, v146, v43
    v_dot2c_f32_bf16 v70, v147, v42
    v_dot2c_f32_bf16 v71, v147, v43
    v_dot2c_f32_bf16 v64, v148, v42
    v_dot2c_f32_bf16 v65, v148, v43
    v_dot2c_f32_bf16 v66, v149, v42
    v_dot2c_f32_bf16 v67, v149, v43
    v_dot2c_f32_bf16 v68, v150, v42
    v_dot2c_f32_bf16 v69, v150, v43
    v_dot2c_f32_bf16 v70, v151, v42
    v_dot2c_f32_bf16 v71, v151, v43
    v_dot2c_f32_bf16 v64, v152, v42
    v_dot2c_f32_bf16 v65, v152, v43
    v_dot2c_f32_bf16 v66, v153, v42
    v_dot2c_f32_bf16 v67, v153, v43
    v_dot2c_f32_bf16 v68, v154, v42
    v_dot2c_f32_bf16 v69, v154, v43
    v_dot2c_f32_bf16 v70, v155, v42
    v_dot2c_f32_bf16 v71, v155, v43
    s_nop 2
    ds_write_b128 v18, v[64:67]
    ds_write_b128 v18, v[68:71] offset:16
    s_waitcnt lgkmcnt(0)
    ds_read2_b32 v[72:73], v19 offset0:0 offset1:68
    ds_read2_b32 v[74:75], v19 offset0:136 offset1:204
    ds_read2_b32 v[76:77], v13 offset0:0 offset1:68
    ds_read2_b32 v[78:79], v13 offset0:136 offset1:204
    s_waitcnt lgkmcnt(0)
    v_add_f32 v72, v72, v76
    v_add_f32 v73, v73, v77
    v_add_f32 v74, v74, v78
    v_add_f32 v75, v75, v79
    v_add_f32 v72, v72, v74
    v_add_f32 v73, v73, v75
    v_add_f32 v72, v72, v73
    ds_write_b32 v15, v72 offset:32768
    s_waitcnt lgkmcnt(0)
    s_barrier
    s_sub_u32 s42, s32, 0
    s_cmp_ge_u32 s42, 1
    s_cbranch_scc1 P1_h1_s
    s_lshl_b32 s42, s32, 11
    v_lshl_add_u32 v45, v1, 2, s42
    ds_read2st64_b32 v[72:73], v45 offset0:128 offset1:129
    ds_read2st64_b32 v[74:75], v45 offset0:130 offset1:131
    ds_read2st64_b32 v[76:77], v45 offset0:132 offset1:133
    ds_read2st64_b32 v[78:79], v45 offset0:134 offset1:135
    s_waitcnt lgkmcnt(0)
    v_add_f32 v72, v72, v76
    v_add_f32 v73, v73, v77
    v_add_f32 v74, v74, v78
    v_add_f32 v75, v75, v79
    v_add_f32 v72, v72, v74
    v_add_f32 v73, v73, v75
    v_add_f32 v72, v72, v73
    v_and_b32 v84, s46, v72
    v_sub_f32 v44, v72, v84
    v_and_b32 v85, s46, v44
    v_sub_f32 v44, v44, v85
    v_and_b32 v86, s46, v44
    v_lshrrev_b32 v87, 16, v84
    v_lshrrev_b32 v88, 16, v85
    v_lshrrev_b32 v89, 16, v86
    v_or_b32 v92, v87, v85
    v_or_b32 v93, v87, v86
    v_or_b32 v94, v88, v84
    v_or_b32 v95, v89, v85
    buffer_store_dwordx4 v[92:95], v2, s[28:31], s38 offen sc1
P1_h1_s:
    s_cmp_lg_u32 s32, 0
    s_cbranch_scc1 P1_h1x
    ds_write_b32 v15, v54 offset:34816
    ds_write_b32 v15, v54 offset:36864
    s_branch P1_h1y
P1_h1x:
    s_add_u32 s39, s41, 32
    s_cmp_lt_u32 s39, 49
    s_cselect_b32 s24, s8, s10
    s_cselect_b32 s25, s9, s11
    s_cselect_b32 s42, 21, 49
    s_movk_i32 s43, 3584
    s_and_b32 s25, s25, 0xffff
    s_mul_i32 s26, s43, 448
    v_mul_u32_u24 v51, s43, v16
    v_lshl_add_u32 v51, v17, 4, v51
    s_sub_u32 s45, s32, 1
    s_lshl_b32 s45, s45, 6
    s_mul_i32 s45, s45, s43
    s_lshl_b32 s44, s43, 3
    s_sub_u32 s42, s39, s42
    s_lshl_b32 s42, s42, 7
    s_add_u32 s37, s45, s42
    buffer_load_dwordx4 v[160:163], v51, s[24:27], s37 offen
    s_add_u32 s37, s37, s44
    buffer_load_dwordx4 v[164:167], v51, s[24:27], s37 offen
    s_add_u32 s37, s37, s44
    buffer_load_dwordx4 v[168:171], v51, s[24:27], s37 offen
    s_add_u32 s37, s37, s44
    buffer_load_dwordx4 v[172:175], v51, s[24:27], s37 offen
    s_add_u32 s37, s37, s44
    buffer_load_dwordx4 v[176:179], v51, s[24:27], s37 offen
    s_add_u32 s37, s37, s44
    buffer_load_dwordx4 v[180:183], v51, s[24:27], s37 offen
    s_add_u32 s37, s37, s44
    buffer_load_dwordx4 v[184:187], v51, s[24:27], s37 offen
    s_add_u32 s37, s37, s44
    buffer_load_dwordx4 v[188:191], v51, s[24:27], s37 offen
    s_add_u32 s39, s41, 64
    s_mov_b64 s[24:25], s[10:11]
    s_movk_i32 s42, 49
    s_and_b32 s25, s25, 0xffff
    s_cmp_lt_u32 s39, 77
    s_cselect_b32 s26, s26, 0
    s_sub_u32 s42, s39, s42
    s_lshl_b32 s42, s42, 7
    s_add_u32 s37, s45, s42
    buffer_load_dwordx4 v[192:195], v51, s[24:27], s37 offen
    s_add_u32 s37, s37, s44
    buffer_load_dwordx4 v[196:199], v51, s[24:27], s37 offen
    s_add_u32 s37, s37, s44
    buffer_load_dwordx4 v[200:203], v51, s[24:27], s37 offen
    s_add_u32 s37, s37, s44
    buffer_load_dwordx4 v[204:207], v51, s[24:27], s37 offen
    s_add_u32 s37, s37, s44
    buffer_load_dwordx4 v[208:211], v51, s[24:27], s37 offen
    s_add_u32 s37, s37, s44
    buffer_load_dwordx4 v[212:215], v51, s[24:27], s37 offen
    s_add_u32 s37, s37, s44
    buffer_load_dwordx4 v[216:219], v51, s[24:27], s37 offen
    s_add_u32 s37, s37, s44
    buffer_load_dwordx4 v[220:223], v51, s[24:27], s37 offen
    v_mov_b64 v[64:65], 0
    v_mov_b64 v[66:67], 0
    v_mov_b64 v[68:69], 0
    v_mov_b64 v[70:71], 0
    s_waitcnt vmcnt(8)
    v_dot2c_f32_bf16 v64, v160, v42
    v_dot2c_f32_bf16 v65, v160, v43
    v_dot2c_f32_bf16 v66, v161, v42
    v_dot2c_f32_bf16 v67, v161, v43
    v_dot2c_f32_bf16 v68, v162, v42
    v_dot2c_f32_bf16 v69, v162, v43
    v_dot2c_f32_bf16 v70, v163, v42
    v_dot2c_f32_bf16 v71, v163, v43
    v_dot2c_f32_bf16 v64, v164, v42
    v_dot2c_f32_bf16 v65, v164, v43
    v_dot2c_f32_bf16 v66, v165, v42
    v_dot2c_f32_bf16 v67, v165, v43
    v_dot2c_f32_bf16 v68, v166, v42
    v_dot2c_f32_bf16 v69, v166, v43
    v_dot2c_f32_bf16 v70, v167, v42
    v_dot2c_f32_bf16 v71, v167, v43
    v_dot2c_f32_bf16 v64, v168, v42
    v_dot2c_f32_bf16 v65, v168, v43
    v_dot2c_f32_bf16 v66, v169, v42
    v_dot2c_f32_bf16 v67, v169, v43
    v_dot2c_f32_bf16 v68, v170, v42
    v_dot2c_f32_bf16 v69, v170, v43
    v_dot2c_f32_bf16 v70, v171, v42
    v_dot2c_f32_bf16 v71, v171, v43
    v_dot2c_f32_bf16 v64, v172, v42
    v_dot2c_f32_bf16 v65, v172, v43
    v_dot2c_f32_bf16 v66, v173, v42
    v_dot2c_f32_bf16 v67, v173, v43
    v_dot2c_f32_bf16 v68, v174, v42
    v_dot2c_f32_bf16 v69, v174, v43
    v_dot2c_f32_bf16 v70, v175, v42
    v_dot2c_f32_bf16 v71, v175, v43
    v_dot2c_f32_bf16 v64, v176, v42
    v_dot2c_f32_bf16 v65, v176, v43
    v_dot2c_f32_bf16 v66, v177, v42
    v_dot2c_f32_bf16 v67, v177, v43
    v_dot2c_f32_bf16 v68, v178, v42
    v_dot2c_f32_bf16 v69, v178, v43
    v_dot2c_f32_bf16 v70, v179, v42
    v_dot2c_f32_bf16 v71, v179, v43
    v_dot2c_f32_bf16 v64, v180, v42
    v_dot2c_f32_bf16 v65, v180, v43
    v_dot2c_f32_bf16 v66, v181, v42
    v_dot2c_f32_bf16 v67, v181, v43
    v_dot2c_f32_bf16 v68, v182, v42
    v_dot2c_f32_bf16 v69, v182, v43
    v_dot2c_f32_bf16 v70, v183, v42
    v_dot2c_f32_bf16 v71, v183, v43
    v_dot2c_f32_bf16 v64, v184, v42
    v_dot2c_f32_bf16 v65, v184, v43
    v_dot2c_f32_bf16 v66, v185, v42
    v_dot2c_f32_bf16 v67, v185, v43
    v_dot2c_f32_bf16 v68, v186, v42
    v_dot2c_f32_bf16 v69, v186, v43
    v_dot2c_f32_bf16 v70, v187, v42
    v_dot2c_f32_bf16 v71, v187, v43
    v_dot2c_f32_bf16 v64, v188, v42
    v_dot2c_f32_bf16 v65, v188, v43
    v_dot2c_f32_bf16 v66, v189, v42
    v_dot2c_f32_bf16 v67, v189, v43
    v_dot2c_f32_bf16 v68, v190, v42
    v_dot2c_f32_bf16 v69, v190, v43
    v_dot2c_f32_bf16 v70, v191, v42
    v_dot2c_f32_bf16 v71, v191, v43
    s_nop 2
    ds_write_b128 v18, v[64:67]
    ds_write_b128 v18, v[68:71] offset:16
    s_waitcnt lgkmcnt(0)
    ds_read2_b32 v[72:73], v19 offset0:0 offset1:68
    ds_read2_b32 v[74:75], v19 offset0:136 offset1:204
    ds_read2_b32 v[76:77], v13 offset0:0 offset1:68
    ds_read2_b32 v[78:79], v13 offset0:136 offset1:204
    s_waitcnt lgkmcnt(0)
    v_add_f32 v72, v72, v76
    v_add_f32 v73, v73, v77
    v_add_f32 v74, v74, v78
    v_add_f32 v75, v75, v79
    v_add_f32 v72, v72, v74
    v_add_f32 v73, v73, v75
    v_add_f32 v72, v72, v73
    ds_write_b32 v15, v72 offset:34816
    v_mov_b64 v[64:65], 0
    v_mov_b64 v[66:67], 0
    v_mov_b64 v[68:69], 0
    v_mov_b64 v[70:71], 0
    s_waitcnt vmcnt(0)
    v_dot2c_f32_bf16 v64, v192, v42
    v_dot2c_f32_bf16 v65, v192, v43
    v_dot2c_f32_bf16 v66, v193, v42
    v_dot2c_f32_bf16 v67, v193, v43
    v_dot2c_f32_bf16 v68, v194, v42
    v_dot2c_f32_bf16 v69, v194, v43
    v_dot2c_f32_bf16 v70, v195, v42
    v_dot2c_f32_bf16 v71, v195, v43
    v_dot2c_f32_bf16 v64, v196, v42
    v_dot2c_f32_bf16 v65, v196, v43
    v_dot2c_f32_bf16 v66, v197, v42
    v_dot2c_f32_bf16 v67, v197, v43
    v_dot2c_f32_bf16 v68, v198, v42
    v_dot2c_f32_bf16 v69, v198, v43
    v_dot2c_f32_bf16 v70, v199, v42
    v_dot2c_f32_bf16 v71, v199, v43
    v_dot2c_f32_bf16 v64, v200, v42
    v_dot2c_f32_bf16 v65, v200, v43
    v_dot2c_f32_bf16 v66, v201, v42
    v_dot2c_f32_bf16 v67, v201, v43
    v_dot2c_f32_bf16 v68, v202, v42
    v_dot2c_f32_bf16 v69, v202, v43
    v_dot2c_f32_bf16 v70, v203, v42
    v_dot2c_f32_bf16 v71, v203, v43
    v_dot2c_f32_bf16 v64, v204, v42
    v_dot2c_f32_bf16 v65, v204, v43
    v_dot2c_f32_bf16 v66, v205, v42
    v_dot2c_f32_bf16 v67, v205, v43
    v_dot2c_f32_bf16 v68, v206, v42
    v_dot2c_f32_bf16 v69, v206, v43
    v_dot2c_f32_bf16 v70, v207, v42
    v_dot2c_f32_bf16 v71, v207, v43
    v_dot2c_f32_bf16 v64, v208, v42
    v_dot2c_f32_bf16 v65, v208, v43
    v_dot2c_f32_bf16 v66, v209, v42
    v_dot2c_f32_bf16 v67, v209, v43
    v_dot2c_f32_bf16 v68, v210, v42
    v_dot2c_f32_bf16 v69, v210, v43
    v_dot2c_f32_bf16 v70, v211, v42
    v_dot2c_f32_bf16 v71, v211, v43
    v_dot2c_f32_bf16 v64, v212, v42
    v_dot2c_f32_bf16 v65, v212, v43
    v_dot2c_f32_bf16 v66, v213, v42
    v_dot2c_f32_bf16 v67, v213, v43
    v_dot2c_f32_bf16 v68, v214, v42
    v_dot2c_f32_bf16 v69, v214, v43
    v_dot2c_f32_bf16 v70, v215, v42
    v_dot2c_f32_bf16 v71, v215, v43
    v_dot2c_f32_bf16 v64, v216, v42
    v_dot2c_f32_bf16 v65, v216, v43
    v_dot2c_f32_bf16 v66, v217, v42
    v_dot2c_f32_bf16 v67, v217, v43
    v_dot2c_f32_bf16 v68, v218, v42
    v_dot2c_f32_bf16 v69, v218, v43
    v_dot2c_f32_bf16 v70, v219, v42
    v_dot2c_f32_bf16 v71, v219, v43
    v_dot2c_f32_bf16 v64, v220, v42
    v_dot2c_f32_bf16 v65, v220, v43
    v_dot2c_f32_bf16 v66, v221, v42
    v_dot2c_f32_bf16 v67, v221, v43
    v_dot2c_f32_bf16 v68, v222, v42
    v_dot2c_f32_bf16 v69, v222, v43
    v_dot2c_f32_bf16 v70, v223, v42
    v_dot2c_f32_bf16 v71, v223, v43
    s_nop 2
    ds_write_b128 v18, v[64:67]
    ds_write_b128 v18, v[68:71] offset:16
    s_waitcnt lgkmcnt(0)
    ds_read2_b32 v[72:73], v19 offset0:0 offset1:68
    ds_read2_b32 v[74:75], v19 offset0:136 offset1:204
    ds_read2_b32 v[76:77], v13 offset0:0 offset1:68
    ds_read2_b32 v[78:79], v13 offset0:136 offset1:204
    s_waitcnt lgkmcnt(0)
    v_add_f32 v72, v72, v76
    v_add_f32 v73, v73, v77
    v_add_f32 v74, v74, v78
    v_add_f32 v75, v75, v79
    v_add_f32 v72, v72, v74
    v_add_f32 v73, v73, v75
    v_add_f32 v72, v72, v73
    ds_write_b32 v15, v72 offset:36864
P1_h1y:
    s_waitcnt lgkmcnt(0)
    s_barrier
    s_sub_u32 s42, s32, 1
    s_cmp_ge_u32 s42, 2
    s_cbranch_scc1 P1_h2_s
    s_lshl_b32 s42, s32, 11
    v_lshl_add_u32 v45, v1, 2, s42
    ds_read2st64_b32 v[72:73], v45 offset0:128 offset1:129
    ds_read2st64_b32 v[74:75], v45 offset0:130 offset1:131
    ds_read2st64_b32 v[76:77], v45 offset0:132 offset1:133
    ds_read2st64_b32 v[78:79], v45 offset0:134 offset1:135
    s_waitcnt lgkmcnt(0)
    v_add_f32 v72, v72, v76
    v_add_f32 v73, v73, v77
    v_add_f32 v74, v74, v78
    v_add_f32 v75, v75, v79
    v_add_f32 v72, v72, v74
    v_add_f32 v73, v73, v75
    v_add_f32 v72, v72, v73
    v_and_b32 v84, s46, v72
    v_sub_f32 v44, v72, v84
    v_and_b32 v85, s46, v44
    v_sub_f32 v44, v44, v85
    v_and_b32 v86, s46, v44
    v_lshrrev_b32 v87, 16, v84
    v_lshrrev_b32 v88, 16, v85
    v_lshrrev_b32 v89, 16, v86
    v_or_b32 v92, v87, v85
    v_or_b32 v93, v87, v86
    v_or_b32 v94, v88, v84
    v_or_b32 v95, v89, v85
    buffer_store_dwordx4 v[92:95], v2, s[28:31], s38 offen sc1
P1_h2_s:
    v_mov_b32 v44, 155652
    v_mov_b32 v45, 4
    ds_write_b32 v44, v45
    v_mov_b32 v15, 0
    s_load_dwordx2 s[4:5], s[0:1], 16
    s_load_dwordx2 s[6:7], s[0:1], 48
    s_lshl_b32 s42, s2, 3
    s_add_u32 s42, s42, s32
    v_lshlrev_b32 v5, 7, v1
    s_mov_b32 s26, 401408
    s_waitcnt lgkmcnt(0)
    s_cmp_lt_u32 s42, 196
    s_cselect_b32 s24, s6, s4
    s_cselect_b32 s25, s7, s5
    s_cselect_b32 s26, 1605632, s26
    s_cselect_b32 s43, 0, 196
    s_and_b32 s25, s25, 0xffff
    s_mov_b32 s27, 0x20000
    s_sub_u32 s42, s42, s43
    s_lshl_b32 s42, s42, 13
    buffer_load_dword v6, v5, s[24:27], s42 offen
    s_mov_b32 s43, 0x4000
    s_cmp_lg_u32 s32, 0
    s_cbranch_scc1 F_hw_ok
F_hw:
    s_sleep 32
    buffer_load_dword v4, v15, s[56:59], 0 offen offset:128 sc1
    s_waitcnt vmcnt(0)
    v_readfirstlane_b32 s42, v4
    s_cmp_eq_u32 s42, 1
    s_cbranch_scc1 F_hw_ok
    s_sub_u32 s43, s43, 1
    s_cbranch_scc0 F_hw
F_hw_ok:
    s_barrier
    s_cmp_lt_u32 s32, 4
    s_cbranch_scc1 F_att
    s_branch F_g2
F_exit:
    s_endpgm
CODE_END:
.section .rodata,"a"
.p2align 6
.amdhsa_kernel parallel_sum__mha_block__glu_gated_geglu__prompt_kernel
  .amdhsa_next_free_vgpr 256
  .amdhsa_next_free_sgpr 64
  .amdhsa_accum_offset 256
  .amdhsa_group_segment_fixed_size 0
  .amdhsa_kernarg_size 80
  .amdhsa_user_sgpr_count 2
  .amdhsa_user_sgpr_kernarg_segment_ptr 1
  .amdhsa_system_sgpr_workgroup_id_x 1
.end_amdhsa_kernel
```
